```python
import torch

def _softmax(x, axis=-1):
    return torch.softmax(x, dim=axis)
def _gelu(x):
    return torch.nn.functional.gelu(x, approximate="tanh")
def _silu(x):
    return torch.nn.functional.silu(x)
def _sigmoid(x):
    return torch.sigmoid(x)
def _layernorm(x, axis=-1, eps=1e-5):
    m = x.mean(dim=axis, keepdim=True)
    v = x.var(dim=axis, keepdim=True, unbiased=False)
    return (x - m) / torch.sqrt(v + eps)
def _scatter_add(tgt, idx, src, axis=0):
    return tgt.clone().index_add_(axis, idx, src)
def _segment_sum(src, seg, n):
    out = torch.zeros((n,) + src.shape[1:], dtype=src.dtype)
    return out.index_add_(0, seg, src)
def _pad(x, pw):
    flat = tuple(v for pair in reversed(pw) for v in pair)
    return torch.nn.functional.pad(x, flat)

kernel_name = 'standalone__gqa_softmax__near_ridge'

def setup_inputs():

    _w = (lambda a: (lambda t: t.to(torch.bfloat16) if t.is_floating_point() else t)(torch.as_tensor(a)))
    B, Hq, Hkv, Sq, Sk, D = 8, 32, 32, 288, 512, 128
    return {
        "q": _w((lambda *s: torch.randn(*s, dtype=torch.bfloat16) * 0.8)(B, Hq, Sq, D)),
        "k": _w((lambda *s: torch.randn(*s, dtype=torch.bfloat16) * 0.8)(B, Hkv, Sk, D)),
        "v": _w((lambda *s: torch.randn(*s, dtype=torch.bfloat16) * 0.05)(B, Hkv, Sk, D)),
    }

def reference(q, k, v):
    B, Hq, Sq, D = q.shape
    Hkv = k.shape[1]
    rep = Hq // Hkv
    k = (lambda x, n, axis: torch.repeat_interleave(x, n, dim=axis))(k, rep, axis=1)
    v = (lambda x, n, axis: torch.repeat_interleave(x, n, dim=axis))(v, rep, axis=1)
    scale = D ** -0.5
    scores = torch.einsum("bhqd,bhkd->bhqk", q, k) * scale
    p = _softmax(scores, axis=-1)
    return torch.einsum("bhqk,bhkd->bhqd", p, v)
```

```asm
; @launch grid=(256,1,1) block=(256,1,1) lds=163840
.amdgcn_target "amdgcn-amd-amdhsa--gfx950"
.text
.p2align 12
.globl standalone__gqa_softmax__near_ridge_kernel
.p2align 8
.type standalone__gqa_softmax__near_ridge_kernel,@function
standalone__gqa_softmax__near_ridge_kernel:
  s_cmp_ge_u32 s2, 256
  s_cbranch_scc1 L_end
  s_load_dwordx4 s[4:7], s[0:1], 0
  s_load_dwordx4 s[8:11], s[0:1], 16
  v_and_b32 v224, 63, v0
  v_lshrrev_b32 v233, 6, v0
  v_mov_b32 v226, 0xff800000
  v_mov_b32 v227, 0xff800000
  v_mov_b32 v228, 0xff800000
  v_mov_b32 v229, 0xff800000
  v_mov_b32 v230, 0xff800000
  v_mov_b32 v231, 0xff800000
  v_readfirstlane_b32 s28, v233
  s_mov_b32 s38, 0
L_RESTART:
  v_bfe_u32 v74, v224, 2, 2
  v_lshlrev_b32 v74, 8, v74
  v_lshrrev_b32 v75, 4, v224
  v_lshl_add_u32 v74, v75, 6, v74
  v_and_b32 v75, 3, v224
  s_lshl_b32 s29, s28, 11
  s_lshl_b32 s39, s28, 1
  s_and_b32 s39, s39, 3
  s_xor_b32 s40, s39, 3
  s_lshl_b32 s43, s28, 14
  v_xor_b32 v76, s39, v75
  v_lshl_add_u32 v220, v76, 4, v74
  v_add_u32 v220, s29, v220
  v_xor_b32 v76, s40, v75
  v_lshl_add_u32 v221, v76, 4, v74
  v_add_u32 v221, s29, v221
  v_xor_b32 v76, 0, v75
  v_lshl_add_u32 v64, v76, 4, v74
  v_xor_b32 v76, 1, v75
  v_lshl_add_u32 v65, v76, 4, v74
  v_xor_b32 v76, 2, v75
  v_lshl_add_u32 v66, v76, 4, v74
  v_xor_b32 v76, 3, v75
  v_lshl_add_u32 v67, v76, 4, v74
  v_add_u32 v222, s29, v64
  v_add_u32 v223, s29, v66
  s_waitcnt lgkmcnt(0)
  s_mul_i32 s41, s2, 73728
  s_add_u32 s12, s4, s41
  s_addc_u32 s13, s5, 0
  s_mov_b32 s14, 73728
  s_mov_b32 s15, 0x20000
  s_add_u32 m0, s43, 90112
  s_mov_b32 s33, s43
  buffer_load_dwordx4 v64, s[12:15], s33 offen nt lds
  buffer_load_dwordx4 v67, s[12:15], s33 offen offset:1024 nt lds
  buffer_load_dwordx4 v66, s[12:15], s33 offen offset:2048 nt lds
  buffer_load_dwordx4 v65, s[12:15], s33 offen offset:3072 nt lds
  s_add_u32 m0, s43, 94208
  s_add_u32 s33, s43, 4096
  buffer_load_dwordx4 v64, s[12:15], s33 offen nt lds
  buffer_load_dwordx4 v67, s[12:15], s33 offen offset:1024 nt lds
  buffer_load_dwordx4 v66, s[12:15], s33 offen offset:2048 nt lds
  buffer_load_dwordx4 v65, s[12:15], s33 offen offset:3072 nt lds
  s_lshl_b32 s40, s2, 17
  s_add_u32 s16, s6, s40
  s_addc_u32 s17, s7, 0
  s_mov_b32 s18, 131072
  s_mov_b32 s19, 0x20000
  s_mov_b32 m0, s29
  s_mov_b32 s30, 0
  buffer_load_dwordx4 v220, s[16:19], s30 offen nt lds
  buffer_load_dwordx4 v221, s[16:19], s30 offen offset:1024 nt lds
  s_add_u32 m0, s43, 98304
  s_add_u32 s33, s43, 8192
  buffer_load_dwordx4 v64, s[12:15], s33 offen nt lds
  buffer_load_dwordx4 v67, s[12:15], s33 offen offset:1024 nt lds
  s_add_u32 s20, s8, s40
  s_addc_u32 s21, s9, 0
  s_mov_b32 s22, 131072
  s_mov_b32 s23, 0x20000
  s_add_u32 s24, s10, s41
  s_addc_u32 s25, s11, 0
  s_mov_b32 s26, 73728
  s_mov_b32 s27, 0x20000
  v_bfe_u32 v76, v224, 2, 2
  v_lshrrev_b32 v75, 4, v224
  v_lshlrev_b32 v208, 10, v76
  v_and_b32 v77, 3, v224
  v_lshl_add_u32 v208, v77, 6, v208
  v_sub_u32 v74, 0, v76
  v_and_b32 v74, 3, v74
  v_xor_b32 v74, v75, v74
  v_lshl_add_u32 v208, v74, 4, v208
  v_lshlrev_b32 v211, 10, v75
  v_lshl_add_u32 v211, v76, 6, v211
  v_and_b32 v74, 1, v75
  v_lshl_add_u32 v211, v74, 5, v211
  v_lshl_add_u32 v211, v77, 3, v211
  v_xor_b32 v214, 32, v211
  v_add_u32 v209, 65536, v208
  v_add_u32 v212, 65536, v211
  v_add_u32 v215, 65536, v214
  v_add_u32 v210, 131072, v208
  v_add_u32 v213, 131072, v211
  v_add_u32 v216, 131072, v214
  s_mov_b32 s67, 24576
  s_mov_b32 s68, 32768
  s_mov_b32 s69, 40960
  s_mov_b32 s70, 49152
  s_mov_b32 s71, 57344
  s_mov_b32 s72, 65536
  s_mov_b32 s73, 73728
  s_mov_b32 s74, 81920
  s_mov_b32 s75, 90112
  s_mov_b32 s76, 98304
  s_mov_b32 s77, 106496
  s_mov_b32 s78, 114688
  s_mov_b32 s79, 122880
  v_mov_b32 v74, 0x3f803f80
  v_mov_b32 v232, 0
  v_accvgpr_write_b32 a224, v74
  v_accvgpr_write_b32 a225, v74
  v_accvgpr_write_b32 a226, v74
  v_accvgpr_write_b32 a227, v74
  s_mov_b32 s34, 0x3e0293ee
  s_mov_b32 s35, 0x3e0293ee
  s_mov_b32 s36, 0xffff0000
  s_mov_b32 s37, 0x4f800000
  s_mov_b32 s31, 0x33800000
  s_mov_b32 s32, 0x1c000000
  s_add_u32 s44, s43, 0
  s_add_u32 s45, s43, 65536
  s_add_u32 s46, s43, 131072
  s_cmp_ge_u32 s46, 163840
  s_cselect_b32 s39, 163840, 0
  s_sub_u32 s46, s46, s39
  s_add_u32 s47, s43, 32768
  v_add_u32 v217, s44, v208
  s_lshl_b32 s61, s28, 8
  v_add_u32 v218, s61, v211
  v_add_u32 v219, s61, v214
  v_lshlrev_b32 v74, 4, v224
  s_add_u32 s41, s43, 90112
  v_add_u32 v68, s41, v208
  s_add_u32 s39, s29, 155648
  v_add_u32 v250, s39, v74
  v_add_u32 v254, 155648, v208
  v_lshlrev_b32 v251, 2, v224
  v_add_u32 v73, s41, v251
  v_add_u32 v251, 90112, v251
  s_mov_b64 exec, 0
  s_lshr_b32 s56, s2, 3
  s_lshl_b32 s56, s56, 2
  s_add_u32 s56, s56, s28
  s_mul_i32 s56, s56, 1
  s_mov_b32 s60, 1
L_TLOOP:
  s_cmp_ge_u32 s56, 104
  s_cselect_b32 s58, 104, 0
  s_sub_u32 s56, s56, s58
  s_cmp_ge_u32 s56, 52
  s_cselect_b32 s58, 52, 0
  s_sub_u32 s56, s56, s58
  s_cmp_ge_u32 s56, 26
  s_cselect_b32 s58, 26, 0
  s_sub_u32 s56, s56, s58
  s_getpc_b64 s[58:59]
  s_lshl_b32 s57, s56, 2
  s_add_u32 s58, s58, s57
  s_addc_u32 s59, s59, 0
  s_add_u32 s58, s58, 24
  s_addc_u32 s59, s59, 0
  s_setpc_b64 s[58:59]
  s_branch TP0
  s_branch TP1
  s_branch TP2
  s_branch TP3
  s_branch TP4
  s_branch TP5
  s_branch TP6
  s_branch TP7
  s_branch TP8
  s_branch TP9
  s_branch TP10
  s_branch TP11
  s_branch TP12
  s_branch TP13
  s_branch TP14
  s_branch TP15
  s_branch TP16
  s_branch TP17
  s_branch TP18
  s_branch TP19
  s_branch TP20
  s_branch TP21
  s_branch TP22
  s_branch TP23
  s_branch TP24
  s_branch TP25
L_TRET:
  s_add_u32 s56, s56, 37
  s_sub_u32 s60, s60, 1
  s_cmp_lg_u32 s60, 0
  s_cbranch_scc1 L_TLOOP
  s_mov_b64 exec, -1
  s_waitcnt vmcnt(8)
  ds_read_b128 v[0:3], v68
  ds_read_b128 v[4:7], v68 offset:256
  ds_read_b128 v[8:11], v68 offset:512
  ds_read_b128 v[12:15], v68 offset:768
  buffer_load_dwordx4 v66, s[12:15], s33 offen offset:2048 nt lds
  buffer_load_dwordx4 v65, s[12:15], s33 offen offset:3072 nt lds
  s_add_u32 m0, s43, 102400
  s_add_u32 s33, s43, 12288
  buffer_load_dwordx4 v64, s[12:15], s33 offen nt lds
  buffer_load_dwordx4 v67, s[12:15], s33 offen offset:1024 nt lds
  s_waitcnt lgkmcnt(3)
  v_lshlrev_b32 v96, 16, v0
  v_lshlrev_b32 v98, 16, v1
  v_lshlrev_b32 v100, 16, v2
  v_lshlrev_b32 v102, 16, v3
  v_and_b32 v97, s36, v0
  v_and_b32 v99, s36, v1
  v_and_b32 v101, s36, v2
  v_and_b32 v103, s36, v3
  v_pk_mul_f32 v[96:97], v[96:97], s[34:35]
  v_pk_mul_f32 v[98:99], v[98:99], s[34:35]
  v_pk_mul_f32 v[100:101], v[100:101], s[34:35]
  v_pk_mul_f32 v[102:103], v[102:103], s[34:35]
  v_cvt_pk_bf16_f32 v0, v96, v97
  v_cvt_pk_bf16_f32 v1, v98, v99
  v_cvt_pk_bf16_f32 v2, v100, v101
  v_cvt_pk_bf16_f32 v3, v102, v103
  v_accvgpr_write_b32 a64, v0
  v_accvgpr_write_b32 a65, v1
  v_accvgpr_write_b32 a66, v2
  v_accvgpr_write_b32 a67, v3
  s_waitcnt lgkmcnt(2)
  v_lshlrev_b32 v104, 16, v4
  v_lshlrev_b32 v106, 16, v5
  v_lshlrev_b32 v108, 16, v6
  v_lshlrev_b32 v110, 16, v7
  v_and_b32 v105, s36, v4
  v_and_b32 v107, s36, v5
  v_and_b32 v109, s36, v6
  v_and_b32 v111, s36, v7
  v_pk_mul_f32 v[104:105], v[104:105], s[34:35]
  v_pk_mul_f32 v[106:107], v[106:107], s[34:35]
  v_pk_mul_f32 v[108:109], v[108:109], s[34:35]
  v_pk_mul_f32 v[110:111], v[110:111], s[34:35]
  v_cvt_pk_bf16_f32 v4, v104, v105
  v_cvt_pk_bf16_f32 v5, v106, v107
  v_cvt_pk_bf16_f32 v6, v108, v109
  v_cvt_pk_bf16_f32 v7, v110, v111
  v_accvgpr_write_b32 a68, v4
  v_accvgpr_write_b32 a69, v5
  v_accvgpr_write_b32 a70, v6
  v_accvgpr_write_b32 a71, v7
  s_waitcnt lgkmcnt(1)
  v_lshlrev_b32 v96, 16, v8
  v_lshlrev_b32 v98, 16, v9
  v_lshlrev_b32 v100, 16, v10
  v_lshlrev_b32 v102, 16, v11
  v_and_b32 v97, s36, v8
  v_and_b32 v99, s36, v9
  v_and_b32 v101, s36, v10
  v_and_b32 v103, s36, v11
  v_pk_mul_f32 v[96:97], v[96:97], s[34:35]
  v_pk_mul_f32 v[98:99], v[98:99], s[34:35]
  v_pk_mul_f32 v[100:101], v[100:101], s[34:35]
  v_pk_mul_f32 v[102:103], v[102:103], s[34:35]
  v_cvt_pk_bf16_f32 v8, v96, v97
  v_cvt_pk_bf16_f32 v9, v98, v99
  v_cvt_pk_bf16_f32 v10, v100, v101
  v_cvt_pk_bf16_f32 v11, v102, v103
  v_accvgpr_write_b32 a72, v8
  v_accvgpr_write_b32 a73, v9
  v_accvgpr_write_b32 a74, v10
  v_accvgpr_write_b32 a75, v11
  s_waitcnt lgkmcnt(0)
  v_lshlrev_b32 v104, 16, v12
  v_lshlrev_b32 v106, 16, v13
  v_lshlrev_b32 v108, 16, v14
  v_lshlrev_b32 v110, 16, v15
  v_and_b32 v105, s36, v12
  v_and_b32 v107, s36, v13
  v_and_b32 v109, s36, v14
  v_and_b32 v111, s36, v15
  v_pk_mul_f32 v[104:105], v[104:105], s[34:35]
  v_pk_mul_f32 v[106:107], v[106:107], s[34:35]
  v_pk_mul_f32 v[108:109], v[108:109], s[34:35]
  v_pk_mul_f32 v[110:111], v[110:111], s[34:35]
  v_cvt_pk_bf16_f32 v12, v104, v105
  v_cvt_pk_bf16_f32 v13, v106, v107
  v_cvt_pk_bf16_f32 v14, v108, v109
  v_cvt_pk_bf16_f32 v15, v110, v111
  v_accvgpr_write_b32 a76, v12
  v_accvgpr_write_b32 a77, v13
  v_accvgpr_write_b32 a78, v14
  v_accvgpr_write_b32 a79, v15
  s_waitcnt vmcnt(8)
  ds_read_b128 v[16:19], v68 offset:4096
  ds_read_b128 v[20:23], v68 offset:4352
  ds_read_b128 v[24:27], v68 offset:4608
  ds_read_b128 v[28:31], v68 offset:4864
  buffer_load_dwordx4 v66, s[12:15], s33 offen offset:2048 nt lds
  buffer_load_dwordx4 v65, s[12:15], s33 offen offset:3072 nt lds
  s_add_u32 m0, s29, 8192
  s_mov_b32 s30, 0
  buffer_load_dwordx4 v222, s[20:23], s30 offen nt lds
  buffer_load_dwordx4 v223, s[20:23], s30 offen offset:1024 nt lds
  s_waitcnt lgkmcnt(3)
  v_lshlrev_b32 v96, 16, v16
  v_lshlrev_b32 v98, 16, v17
  v_lshlrev_b32 v100, 16, v18
  v_lshlrev_b32 v102, 16, v19
  v_and_b32 v97, s36, v16
  v_and_b32 v99, s36, v17
  v_and_b32 v101, s36, v18
  v_and_b32 v103, s36, v19
  v_pk_mul_f32 v[96:97], v[96:97], s[34:35]
  v_pk_mul_f32 v[98:99], v[98:99], s[34:35]
  v_pk_mul_f32 v[100:101], v[100:101], s[34:35]
  v_pk_mul_f32 v[102:103], v[102:103], s[34:35]
  v_cvt_pk_bf16_f32 v16, v96, v97
  v_cvt_pk_bf16_f32 v17, v98, v99
  v_cvt_pk_bf16_f32 v18, v100, v101
  v_cvt_pk_bf16_f32 v19, v102, v103
  v_accvgpr_write_b32 a80, v16
  v_accvgpr_write_b32 a81, v17
  v_accvgpr_write_b32 a82, v18
  v_accvgpr_write_b32 a83, v19
  s_waitcnt lgkmcnt(2)
  v_lshlrev_b32 v104, 16, v20
  v_lshlrev_b32 v106, 16, v21
  v_lshlrev_b32 v108, 16, v22
  v_lshlrev_b32 v110, 16, v23
  v_and_b32 v105, s36, v20
  v_and_b32 v107, s36, v21
  v_and_b32 v109, s36, v22
  v_and_b32 v111, s36, v23
  v_pk_mul_f32 v[104:105], v[104:105], s[34:35]
  v_pk_mul_f32 v[106:107], v[106:107], s[34:35]
  v_pk_mul_f32 v[108:109], v[108:109], s[34:35]
  v_pk_mul_f32 v[110:111], v[110:111], s[34:35]
  v_cvt_pk_bf16_f32 v20, v104, v105
  v_cvt_pk_bf16_f32 v21, v106, v107
  v_cvt_pk_bf16_f32 v22, v108, v109
  v_cvt_pk_bf16_f32 v23, v110, v111
  v_accvgpr_write_b32 a84, v20
  v_accvgpr_write_b32 a85, v21
  v_accvgpr_write_b32 a86, v22
  v_accvgpr_write_b32 a87, v23
  s_waitcnt lgkmcnt(1)
TP0:
  s_cbranch_execz L_TRET
  v_lshlrev_b32 v96, 16, v24
  v_lshlrev_b32 v98, 16, v25
  v_lshlrev_b32 v100, 16, v26
  v_lshlrev_b32 v102, 16, v27
  v_and_b32 v97, s36, v24
  v_and_b32 v99, s36, v25
  v_and_b32 v101, s36, v26
  v_and_b32 v103, s36, v27
  v_pk_mul_f32 v[96:97], v[96:97], s[34:35]
  v_pk_mul_f32 v[98:99], v[98:99], s[34:35]
  v_pk_mul_f32 v[100:101], v[100:101], s[34:35]
  v_pk_mul_f32 v[102:103], v[102:103], s[34:35]
  v_cvt_pk_bf16_f32 v24, v96, v97
  v_cvt_pk_bf16_f32 v25, v98, v99
  v_cvt_pk_bf16_f32 v26, v100, v101
  v_cvt_pk_bf16_f32 v27, v102, v103
  v_accvgpr_write_b32 a88, v24
  v_accvgpr_write_b32 a89, v25
  v_accvgpr_write_b32 a90, v26
  v_accvgpr_write_b32 a91, v27
  s_waitcnt lgkmcnt(0)
  v_lshlrev_b32 v104, 16, v28
  v_lshlrev_b32 v106, 16, v29
  v_lshlrev_b32 v108, 16, v30
  v_lshlrev_b32 v110, 16, v31
  v_and_b32 v105, s36, v28
  v_and_b32 v107, s36, v29
  v_and_b32 v109, s36, v30
  v_and_b32 v111, s36, v31
  v_pk_mul_f32 v[104:105], v[104:105], s[34:35]
  v_pk_mul_f32 v[106:107], v[106:107], s[34:35]
  v_pk_mul_f32 v[108:109], v[108:109], s[34:35]
  v_pk_mul_f32 v[110:111], v[110:111], s[34:35]
  v_cvt_pk_bf16_f32 v28, v104, v105
  v_cvt_pk_bf16_f32 v29, v106, v107
  v_cvt_pk_bf16_f32 v30, v108, v109
  v_cvt_pk_bf16_f32 v31, v110, v111
  v_accvgpr_write_b32 a92, v28
  v_accvgpr_write_b32 a93, v29
  v_accvgpr_write_b32 a94, v30
  v_accvgpr_write_b32 a95, v31
  s_waitcnt vmcnt(10)
  s_barrier
  ds_read_b128 a[160:163], v208
  ds_read_b128 a[164:167], v208 offset:256
  ds_read_b128 a[168:171], v208 offset:512
  ds_read_b128 a[172:175], v208 offset:768
  ds_read_b128 a[176:179], v208 offset:4096
  ds_read_b128 a[180:183], v208 offset:4352
  ds_read_b128 a[184:187], v208 offset:4608
  ds_read_b128 a[188:191], v208 offset:4864
  s_add_u32 m0, s29, 16384
  s_mov_b32 s30, 8192
  buffer_load_dwordx4 v220, s[16:19], s30 offen nt lds
  buffer_load_dwordx4 v221, s[16:19], s30 offen offset:1024 nt lds
  s_waitcnt lgkmcnt(7)
  v_mfma_f32_16x16x32_bf16 v[128:131], a[160:163], a[64:67], 0
  s_waitcnt lgkmcnt(6)
  v_mfma_f32_16x16x32_bf16 v[128:131], a[164:167], a[68:71], v[128:131]
  s_waitcnt lgkmcnt(5)
  v_mfma_f32_16x16x32_bf16 v[128:131], a[168:171], a[72:75], v[128:131]
  s_waitcnt lgkmcnt(4)
  v_mfma_f32_16x16x32_bf16 v[128:131], a[172:175], a[76:79], v[128:131]
  s_waitcnt lgkmcnt(3)
  v_mfma_f32_16x16x32_bf16 v[132:135], a[176:179], a[64:67], 0
  s_waitcnt lgkmcnt(2)
  v_mfma_f32_16x16x32_bf16 v[132:135], a[180:183], a[68:71], v[132:135]
  s_waitcnt lgkmcnt(1)
  v_mfma_f32_16x16x32_bf16 v[132:135], a[184:187], a[72:75], v[132:135]
  s_waitcnt lgkmcnt(0)
  v_mfma_f32_16x16x32_bf16 v[132:135], a[188:191], a[76:79], v[132:135]
  v_mfma_f32_16x16x32_bf16 v[136:139], a[160:163], a[80:83], 0
  v_mfma_f32_16x16x32_bf16 v[136:139], a[164:167], a[84:87], v[136:139]
  v_mfma_f32_16x16x32_bf16 v[136:139], a[168:171], a[88:91], v[136:139]
  v_mfma_f32_16x16x32_bf16 v[136:139], a[172:175], a[92:95], v[136:139]
  v_mfma_f32_16x16x32_bf16 v[140:143], a[176:179], a[80:83], 0
  v_mfma_f32_16x16x32_bf16 v[140:143], a[180:183], a[84:87], v[140:143]
  v_mfma_f32_16x16x32_bf16 v[140:143], a[184:187], a[88:91], v[140:143]
  v_mfma_f32_16x16x32_bf16 v[140:143], a[188:191], a[92:95], v[140:143]
  v_max3_f32 v226, v226, v128, v129
  s_nop 2
  v_max3_f32 v227, v227, v136, v137
  v_max3_f32 v226, v226, v130, v131
  v_max3_f32 v227, v227, v138, v139
  v_max3_f32 v226, v226, v132, v133
  v_max3_f32 v227, v227, v140, v141
  v_max3_f32 v226, v226, v134, v135
  v_max3_f32 v227, v227, v142, v143
  v_mov_b32 v74, v226
  v_mov_b32 v75, v227
  s_nop 0
  v_permlane16_swap_b32 v226, v74
  v_permlane16_swap_b32 v227, v75
  s_nop 0
  v_max_f32 v226, v226, v74
  v_max_f32 v227, v227, v75
  v_mov_b32 v74, v226
  v_mov_b32 v75, v227
  s_nop 0
  v_permlane32_swap_b32 v226, v74
  v_permlane32_swap_b32 v227, v75
  s_nop 0
  v_max_f32 v226, v226, v74
  v_max_f32 v227, v227, v75
  v_sub_f32 v160, 0, v226
  v_sub_f32 v164, 0, v227
  v_mov_b32 v161, v160
  v_mov_b32 v165, v164
  v_mov_b32 v162, v160
  v_mov_b32 v166, v164
  v_mov_b32 v163, v160
  v_mov_b32 v167, v164
  ds_write_b32 v73, v226
  ds_write_b32 v73, v227 offset:256
  v_add_f32 v128, v128, v160
  v_add_f32 v129, v129, v160
  v_add_f32 v130, v130, v160
  v_add_f32 v131, v131, v160
  v_add_f32 v132, v132, v160
  v_add_f32 v133, v133, v160
  v_add_f32 v134, v134, v160
  v_add_f32 v135, v135, v160
  v_add_f32 v136, v136, v164
  v_add_f32 v137, v137, v164
  v_add_f32 v138, v138, v164
  v_add_f32 v139, v139, v164
  v_add_f32 v140, v140, v164
  v_add_f32 v141, v141, v164
  v_add_f32 v142, v142, v164
  v_add_f32 v143, v143, v164
  v_exp_f32 v128, v128
  v_exp_f32 v129, v129
  v_exp_f32 v130, v130
  v_cvt_pk_bf16_f32 v128, v128, v129
  v_exp_f32 v131, v131
  v_exp_f32 v132, v132
  v_cvt_pk_bf16_f32 v129, v130, v131
  v_exp_f32 v133, v133
  v_exp_f32 v134, v134
  v_cvt_pk_bf16_f32 v130, v132, v133
  v_exp_f32 v135, v135
  s_nop 0
  v_cvt_pk_bf16_f32 v131, v134, v135
  v_exp_f32 v136, v136
  v_exp_f32 v137, v137
  v_exp_f32 v138, v138
  v_cvt_pk_bf16_f32 v136, v136, v137
  v_exp_f32 v139, v139
  v_exp_f32 v140, v140
  v_cvt_pk_bf16_f32 v137, v138, v139
  v_exp_f32 v141, v141
  v_exp_f32 v142, v142
  v_cvt_pk_bf16_f32 v138, v140, v141
  v_exp_f32 v143, v143
  s_nop 0
  v_cvt_pk_bf16_f32 v139, v142, v143
  s_waitcnt vmcnt(8)
  ds_read_b128 v[32:35], v68 offset:8192
  ds_read_b128 v[36:39], v68 offset:8448
  ds_read_b128 v[40:43], v68 offset:8704
  ds_read_b128 v[44:47], v68 offset:8960
  s_add_u32 m0, s29, 24576
  s_mov_b32 s30, 8192
  buffer_load_dwordx4 v222, s[20:23], s30 offen nt lds
  buffer_load_dwordx4 v223, s[20:23], s30 offen offset:1024 nt lds
  s_add_u32 m0, s29, 32768
  s_mov_b32 s30, 16384
  buffer_load_dwordx4 v220, s[16:19], s30 offen nt lds
  buffer_load_dwordx4 v221, s[16:19], s30 offen offset:1024 nt lds
  s_waitcnt lgkmcnt(3)
  v_lshlrev_b32 v96, 16, v32
  v_lshlrev_b32 v98, 16, v33
  v_lshlrev_b32 v100, 16, v34
TP1:
  s_cbranch_execz L_TRET
  v_lshlrev_b32 v102, 16, v35
  v_and_b32 v97, s36, v32
  v_and_b32 v99, s36, v33
  v_and_b32 v101, s36, v34
  v_and_b32 v103, s36, v35
  v_mul_f32 v96, s34, v96
  v_mul_f32 v97, s34, v97
  v_mul_f32 v98, s34, v98
  v_mul_f32 v99, s34, v99
  v_mul_f32 v100, s34, v100
  v_mul_f32 v101, s34, v101
  v_mul_f32 v102, s34, v102
  v_mul_f32 v103, s34, v103
  v_cvt_pk_bf16_f32 v32, v96, v97
  v_cvt_pk_bf16_f32 v33, v98, v99
  v_cvt_pk_bf16_f32 v34, v100, v101
  v_cvt_pk_bf16_f32 v35, v102, v103
  v_accvgpr_write_b32 a96, v32
  v_accvgpr_write_b32 a97, v33
  v_accvgpr_write_b32 a98, v34
  v_accvgpr_write_b32 a99, v35
  s_waitcnt lgkmcnt(2)
  v_lshlrev_b32 v104, 16, v36
  v_lshlrev_b32 v106, 16, v37
  v_lshlrev_b32 v108, 16, v38
  v_lshlrev_b32 v110, 16, v39
  v_and_b32 v105, s36, v36
  v_and_b32 v107, s36, v37
  v_and_b32 v109, s36, v38
  v_and_b32 v111, s36, v39
  v_mfma_f32_16x16x32_bf16 v[144:147], a[160:163], a[96:99], 0
  v_mul_f32 v104, s34, v104
  v_mul_f32 v105, s34, v105
  v_mul_f32 v106, s34, v106
  v_mul_f32 v107, s34, v107
  v_mul_f32 v108, s34, v108
  v_mul_f32 v109, s34, v109
  v_mul_f32 v110, s34, v110
  v_mul_f32 v111, s34, v111
  v_mfma_f32_16x16x32_bf16 v[148:151], a[176:179], a[96:99], 0
  v_cvt_pk_bf16_f32 v36, v104, v105
  v_cvt_pk_bf16_f32 v37, v106, v107
  v_cvt_pk_bf16_f32 v38, v108, v109
  v_cvt_pk_bf16_f32 v39, v110, v111
  v_accvgpr_write_b32 a100, v36
  v_accvgpr_write_b32 a101, v37
  v_accvgpr_write_b32 a102, v38
  v_accvgpr_write_b32 a103, v39
  s_waitcnt lgkmcnt(1)
  v_lshlrev_b32 v96, 16, v40
  v_lshlrev_b32 v98, 16, v41
  v_lshlrev_b32 v100, 16, v42
  v_lshlrev_b32 v102, 16, v43
  v_and_b32 v97, s36, v40
  v_and_b32 v99, s36, v41
  v_and_b32 v101, s36, v42
  v_and_b32 v103, s36, v43
  v_mfma_f32_16x16x32_bf16 v[144:147], a[164:167], a[100:103], v[144:147]
  v_mul_f32 v96, s34, v96
  v_mul_f32 v97, s34, v97
  v_mul_f32 v98, s34, v98
  v_mul_f32 v99, s34, v99
  v_mul_f32 v100, s34, v100
  v_mul_f32 v101, s34, v101
  v_mul_f32 v102, s34, v102
  v_mul_f32 v103, s34, v103
  v_mfma_f32_16x16x32_bf16 v[148:151], a[180:183], a[100:103], v[148:151]
  v_cvt_pk_bf16_f32 v40, v96, v97
  v_cvt_pk_bf16_f32 v41, v98, v99
  v_cvt_pk_bf16_f32 v42, v100, v101
  v_cvt_pk_bf16_f32 v43, v102, v103
  v_accvgpr_write_b32 a104, v40
  v_accvgpr_write_b32 a105, v41
  v_accvgpr_write_b32 a106, v42
  v_accvgpr_write_b32 a107, v43
  s_waitcnt lgkmcnt(0)
  v_lshlrev_b32 v104, 16, v44
  v_lshlrev_b32 v106, 16, v45
  v_lshlrev_b32 v108, 16, v46
  v_lshlrev_b32 v110, 16, v47
  v_and_b32 v105, s36, v44
  v_and_b32 v107, s36, v45
  v_and_b32 v109, s36, v46
  v_and_b32 v111, s36, v47
  v_mfma_f32_16x16x32_bf16 v[144:147], a[168:171], a[104:107], v[144:147]
  v_mul_f32 v104, s34, v104
  v_mul_f32 v105, s34, v105
  v_mul_f32 v106, s34, v106
  v_mul_f32 v107, s34, v107
  v_mul_f32 v108, s34, v108
  v_mul_f32 v109, s34, v109
  v_mul_f32 v110, s34, v110
  v_mul_f32 v111, s34, v111
  v_mfma_f32_16x16x32_bf16 v[148:151], a[184:187], a[104:107], v[148:151]
  v_cvt_pk_bf16_f32 v44, v104, v105
  v_cvt_pk_bf16_f32 v45, v106, v107
  v_cvt_pk_bf16_f32 v46, v108, v109
  v_cvt_pk_bf16_f32 v47, v110, v111
  v_accvgpr_write_b32 a108, v44
  v_accvgpr_write_b32 a109, v45
  v_accvgpr_write_b32 a110, v46
  v_accvgpr_write_b32 a111, v47
  s_nop 1
  v_mfma_f32_16x16x32_bf16 v[144:147], a[172:175], a[108:111], v[144:147]
  v_mfma_f32_16x16x32_bf16 v[148:151], a[188:191], a[108:111], v[148:151]
  s_nop 6
  v_max3_f32 v228, v228, v144, v145
  v_max3_f32 v228, v228, v146, v147
  v_max3_f32 v228, v228, v148, v149
  v_max3_f32 v228, v228, v150, v151
  v_mov_b32 v74, v228
  s_nop 1
  v_permlane16_swap_b32 v228, v74
  s_nop 1
  v_max_f32 v228, v228, v74
  v_mov_b32 v74, v228
  s_nop 1
  v_permlane32_swap_b32 v228, v74
  s_nop 1
  v_max_f32 v228, v228, v74
  v_sub_f32 v168, 0, v228
  v_sub_f32 v169, 0, v228
  v_sub_f32 v170, 0, v228
  v_sub_f32 v171, 0, v228
  v_add_f32 v144, v144, v168
  v_add_f32 v145, v145, v168
  v_add_f32 v146, v146, v168
  v_add_f32 v147, v147, v168
  v_add_f32 v148, v148, v168
  v_add_f32 v149, v149, v168
  v_add_f32 v150, v150, v168
  v_add_f32 v151, v151, v168
  v_exp_f32 v144, v144
  v_exp_f32 v145, v145
  v_exp_f32 v146, v146
  v_cvt_pk_bf16_f32 v144, v144, v145
  v_exp_f32 v147, v147
  v_exp_f32 v148, v148
  v_cvt_pk_bf16_f32 v145, v146, v147
  v_exp_f32 v149, v149
  v_exp_f32 v150, v150
  v_cvt_pk_bf16_f32 v146, v148, v149
  v_exp_f32 v151, v151
  s_nop 0
  v_cvt_pk_bf16_f32 v147, v150, v151
  s_waitcnt vmcnt(8)
  ds_read_b128 v[48:51], v68 offset:12288
  ds_read_b128 v[52:55], v68 offset:12544
  ds_read_b128 v[56:59], v68 offset:12800
  ds_read_b128 v[60:63], v68 offset:13056
  s_add_u32 m0, s29, 40960
  s_mov_b32 s30, 16384
  buffer_load_dwordx4 v222, s[20:23], s30 offen nt lds
  buffer_load_dwordx4 v223, s[20:23], s30 offen offset:1024 nt lds
  s_add_u32 m0, s29, 49152
  s_mov_b32 s30, 24576
  buffer_load_dwordx4 v220, s[16:19], s30 offen nt lds
  buffer_load_dwordx4 v221, s[16:19], s30 offen offset:1024 nt lds
  s_waitcnt lgkmcnt(3)
  v_lshlrev_b32 v96, 16, v48
  v_lshlrev_b32 v98, 16, v49
  v_lshlrev_b32 v100, 16, v50
  v_lshlrev_b32 v102, 16, v51
  v_and_b32 v97, s36, v48
  v_and_b32 v99, s36, v49
  v_and_b32 v101, s36, v50
  v_and_b32 v103, s36, v51
  v_mul_f32 v96, s34, v96
  v_mul_f32 v97, s34, v97
  v_mul_f32 v98, s34, v98
  v_mul_f32 v99, s34, v99
  v_mul_f32 v100, s34, v100
  v_mul_f32 v101, s34, v101
  v_mul_f32 v102, s34, v102
  v_mul_f32 v103, s34, v103
  v_cvt_pk_bf16_f32 v48, v96, v97
  v_cvt_pk_bf16_f32 v49, v98, v99
  v_cvt_pk_bf16_f32 v50, v100, v101
  v_cvt_pk_bf16_f32 v51, v102, v103
  v_accvgpr_write_b32 a112, v48
  v_accvgpr_write_b32 a113, v49
  v_accvgpr_write_b32 a114, v50
  v_accvgpr_write_b32 a115, v51
  s_waitcnt lgkmcnt(2)
  v_lshlrev_b32 v104, 16, v52
  v_lshlrev_b32 v106, 16, v53
  v_lshlrev_b32 v108, 16, v54
TP2:
  s_cbranch_execz L_TRET
  v_lshlrev_b32 v110, 16, v55
  v_and_b32 v105, s36, v52
  v_and_b32 v107, s36, v53
  v_and_b32 v109, s36, v54
  v_and_b32 v111, s36, v55
  v_mfma_f32_16x16x32_bf16 v[152:155], a[160:163], a[112:115], 0
  v_mul_f32 v104, s34, v104
  v_mul_f32 v105, s34, v105
  v_mul_f32 v106, s34, v106
  v_mul_f32 v107, s34, v107
  v_mul_f32 v108, s34, v108
  v_mul_f32 v109, s34, v109
  v_mul_f32 v110, s34, v110
  v_mul_f32 v111, s34, v111
  v_mfma_f32_16x16x32_bf16 v[156:159], a[176:179], a[112:115], 0
  v_cvt_pk_bf16_f32 v52, v104, v105
  v_cvt_pk_bf16_f32 v53, v106, v107
  v_cvt_pk_bf16_f32 v54, v108, v109
  v_cvt_pk_bf16_f32 v55, v110, v111
  v_accvgpr_write_b32 a116, v52
  v_accvgpr_write_b32 a117, v53
  v_accvgpr_write_b32 a118, v54
  v_accvgpr_write_b32 a119, v55
  s_waitcnt lgkmcnt(1)
  v_lshlrev_b32 v96, 16, v56
  v_lshlrev_b32 v98, 16, v57
  v_lshlrev_b32 v100, 16, v58
  v_lshlrev_b32 v102, 16, v59
  v_and_b32 v97, s36, v56
  v_and_b32 v99, s36, v57
  v_and_b32 v101, s36, v58
  v_and_b32 v103, s36, v59
  v_mfma_f32_16x16x32_bf16 v[152:155], a[164:167], a[116:119], v[152:155]
  v_mul_f32 v96, s34, v96
  v_mul_f32 v97, s34, v97
  v_mul_f32 v98, s34, v98
  v_mul_f32 v99, s34, v99
  v_mul_f32 v100, s34, v100
  v_mul_f32 v101, s34, v101
  v_mul_f32 v102, s34, v102
  v_mul_f32 v103, s34, v103
  v_mfma_f32_16x16x32_bf16 v[156:159], a[180:183], a[116:119], v[156:159]
  v_cvt_pk_bf16_f32 v56, v96, v97
  v_cvt_pk_bf16_f32 v57, v98, v99
  v_cvt_pk_bf16_f32 v58, v100, v101
  v_cvt_pk_bf16_f32 v59, v102, v103
  v_accvgpr_write_b32 a120, v56
  v_accvgpr_write_b32 a121, v57
  v_accvgpr_write_b32 a122, v58
  v_accvgpr_write_b32 a123, v59
  s_waitcnt lgkmcnt(0)
  v_lshlrev_b32 v104, 16, v60
  v_lshlrev_b32 v106, 16, v61
  v_lshlrev_b32 v108, 16, v62
  v_lshlrev_b32 v110, 16, v63
  v_and_b32 v105, s36, v60
  v_and_b32 v107, s36, v61
  v_and_b32 v109, s36, v62
  v_and_b32 v111, s36, v63
  v_mfma_f32_16x16x32_bf16 v[152:155], a[168:171], a[120:123], v[152:155]
  v_mul_f32 v104, s34, v104
  v_mul_f32 v105, s34, v105
  v_mul_f32 v106, s34, v106
  v_mul_f32 v107, s34, v107
  v_mul_f32 v108, s34, v108
  v_mul_f32 v109, s34, v109
  v_mul_f32 v110, s34, v110
  v_mul_f32 v111, s34, v111
  v_mfma_f32_16x16x32_bf16 v[156:159], a[184:187], a[120:123], v[156:159]
  v_cvt_pk_bf16_f32 v60, v104, v105
  v_cvt_pk_bf16_f32 v61, v106, v107
  v_cvt_pk_bf16_f32 v62, v108, v109
  v_cvt_pk_bf16_f32 v63, v110, v111
  v_accvgpr_write_b32 a124, v60
  v_accvgpr_write_b32 a125, v61
  v_accvgpr_write_b32 a126, v62
  v_accvgpr_write_b32 a127, v63
  s_nop 1
  v_mfma_f32_16x16x32_bf16 v[152:155], a[172:175], a[124:127], v[152:155]
  v_mfma_f32_16x16x32_bf16 v[156:159], a[188:191], a[124:127], v[156:159]
  s_waitcnt vmcnt(10)
  s_barrier
  ds_read_b64_tr_b16 a[192:193], v211 offset:8192
  ds_read_b64_tr_b16 a[194:195], v211 offset:12288
  ds_read_b64_tr_b16 a[196:197], v214 offset:8192
  ds_read_b64_tr_b16 a[198:199], v214 offset:12288
  ds_read_b64_tr_b16 a[200:201], v211 offset:8448
  ds_read_b64_tr_b16 a[202:203], v211 offset:12544
  ds_read_b64_tr_b16 a[204:205], v214 offset:8448
  ds_read_b64_tr_b16 a[206:207], v214 offset:12544
  ds_read_b64_tr_b16 a[208:209], v211 offset:8704
  ds_read_b64_tr_b16 a[210:211], v211 offset:12800
  ds_read_b64_tr_b16 a[212:213], v214 offset:8704
  ds_read_b64_tr_b16 a[214:215], v214 offset:12800
  ds_read_b64_tr_b16 a[216:217], v211 offset:8960
  ds_read_b64_tr_b16 a[218:219], v211 offset:13056
  ds_read_b64_tr_b16 a[220:221], v214 offset:8960
  ds_read_b64_tr_b16 a[222:223], v214 offset:13056
  ds_read_b32 v252, v251
  ds_read_b32 v253, v251 offset:256
  s_add_u32 m0, s29, 57344
  s_mov_b32 s30, 24576
  buffer_load_dwordx4 v222, s[20:23], s30 offen nt lds
  buffer_load_dwordx4 v223, s[20:23], s30 offen offset:1024 nt lds
  v_max3_f32 v229, v229, v152, v153
  v_max3_f32 v229, v229, v154, v155
  v_max3_f32 v229, v229, v156, v157
  v_max3_f32 v229, v229, v158, v159
  v_mov_b32 v74, v229
  s_nop 1
  v_permlane16_swap_b32 v229, v74
  s_nop 1
  v_max_f32 v229, v229, v74
  v_mov_b32 v74, v229
  s_nop 1
  v_permlane32_swap_b32 v229, v74
  s_nop 1
  v_max_f32 v229, v229, v74
  v_sub_f32 v172, 0, v229
  v_sub_f32 v173, 0, v229
  v_sub_f32 v174, 0, v229
  v_sub_f32 v175, 0, v229
  s_waitcnt lgkmcnt(15)
  v_mfma_f32_16x16x32_bf16 v[0:3], a[192:195], v[128:131], 0
  v_add_f32 v152, v152, v172
  v_add_f32 v153, v153, v172
  s_waitcnt lgkmcnt(14)
  v_mfma_f32_16x16x32_bf16 v[4:7], a[196:199], v[128:131], 0
  v_add_f32 v154, v154, v172
  s_waitcnt lgkmcnt(12)
  v_mfma_f32_16x16x32_bf16 v[8:11], a[200:203], v[128:131], 0
  v_add_f32 v155, v155, v172
  s_waitcnt lgkmcnt(10)
  v_mfma_f32_16x16x32_bf16 v[12:15], a[204:207], v[128:131], 0
  v_add_f32 v156, v156, v172
  s_waitcnt lgkmcnt(8)
  v_mfma_f32_16x16x32_bf16 v[16:19], a[208:211], v[128:131], 0
  v_add_f32 v157, v157, v172
  s_waitcnt lgkmcnt(6)
  v_mfma_f32_16x16x32_bf16 v[20:23], a[212:215], v[128:131], 0
  v_add_f32 v158, v158, v172
  s_waitcnt lgkmcnt(4)
  v_mfma_f32_16x16x32_bf16 v[24:27], a[216:219], v[128:131], 0
  v_add_f32 v159, v159, v172
  v_exp_f32 v152, v152
  s_waitcnt lgkmcnt(2)
  v_mfma_f32_16x16x32_bf16 v[28:31], a[220:223], v[128:131], 0
  v_exp_f32 v153, v153
  v_mfma_f32_16x16x32_bf16 v[184:187], a[224:227], v[128:131], 0
  v_exp_f32 v154, v154
  v_mfma_f32_16x16x32_bf16 v[32:35], a[192:195], v[136:139], 0
  v_cvt_pk_bf16_f32 v152, v152, v153
  v_mfma_f32_16x16x32_bf16 v[36:39], a[196:199], v[136:139], 0
  v_exp_f32 v155, v155
  v_mfma_f32_16x16x32_bf16 v[40:43], a[200:203], v[136:139], 0
  v_exp_f32 v156, v156
  v_mfma_f32_16x16x32_bf16 v[44:47], a[204:207], v[136:139], 0
  v_cvt_pk_bf16_f32 v153, v154, v155
  v_exp_f32 v157, v157
  v_mfma_f32_16x16x32_bf16 v[48:51], a[208:211], v[136:139], 0
  v_exp_f32 v158, v158
  v_mfma_f32_16x16x32_bf16 v[52:55], a[212:215], v[136:139], 0
  v_cvt_pk_bf16_f32 v154, v156, v157
TP3:
  s_cbranch_execz L_TRET
  v_mfma_f32_16x16x32_bf16 v[56:59], a[216:219], v[136:139], 0
  v_exp_f32 v159, v159
  v_mfma_f32_16x16x32_bf16 v[60:63], a[220:223], v[136:139], 0
  s_nop 0
  v_mfma_f32_16x16x32_bf16 v[188:191], a[224:227], v[136:139], 0
  v_cvt_pk_bf16_f32 v155, v158, v159
  v_mfma_f32_16x16x32_bf16 v[64:67], a[192:195], v[144:147], 0
  s_cmp_eq_u32 s38, 0
  s_cselect_b64 vcc, -1, 0
  s_waitcnt lgkmcnt(0)
  v_cndmask_b32 v230, v230, v252, vcc
  v_mfma_f32_16x16x32_bf16 v[68:71], a[196:199], v[144:147], 0
  v_cndmask_b32 v231, v231, v253, vcc
  v_mov_b32 v252, v230
  v_mfma_f32_16x16x32_bf16 v[72:75], a[200:203], v[144:147], 0
  v_mov_b32 v253, v231
  v_permlane16_swap_b32 v230, v252
  s_nop 0
  v_permlane16_swap_b32 v231, v253
  v_mfma_f32_16x16x32_bf16 v[76:79], a[204:207], v[144:147], 0
  v_max_f32 v230, v230, v252
  v_max_f32 v231, v231, v253
  v_mfma_f32_16x16x32_bf16 v[80:83], a[208:211], v[144:147], 0
  v_mov_b32 v252, v230
  v_mov_b32 v253, v231
  v_mfma_f32_16x16x32_bf16 v[84:87], a[212:215], v[144:147], 0
  v_permlane32_swap_b32 v230, v252
  v_permlane32_swap_b32 v231, v253
  v_max_f32 v230, v230, v252
  v_mfma_f32_16x16x32_bf16 v[88:91], a[216:219], v[144:147], 0
  v_max_f32 v231, v231, v253
  v_sub_f32 v176, 0, v230
  v_mfma_f32_16x16x32_bf16 v[92:95], a[220:223], v[144:147], 0
  v_sub_f32 v180, 0, v231
  v_mov_b32 v177, v176
  v_mov_b32 v181, v180
  v_mfma_f32_16x16x32_bf16 v[192:195], a[224:227], v[144:147], 0
  v_mov_b32 v178, v176
  v_mov_b32 v182, v180
  v_mfma_f32_16x16x32_bf16 v[96:99], a[192:195], v[152:155], 0
  v_mov_b32 v179, v176
  v_mov_b32 v183, v180
  s_waitcnt vmcnt(10)
  s_barrier
  ds_read_b128 a[160:163], v208 offset:16384
  ds_read_b128 a[164:167], v208 offset:16640
  ds_read_b128 a[168:171], v208 offset:16896
  ds_read_b128 a[172:175], v208 offset:17152
  ds_read_b128 a[176:179], v208 offset:20480
  ds_read_b128 a[180:183], v208 offset:20736
  ds_read_b128 a[184:187], v208 offset:20992
  ds_read_b128 a[188:191], v208 offset:21248
  s_add_u32 m0, s29, 65536
  s_mov_b32 s30, 32768
  buffer_load_dwordx4 v220, s[16:19], s30 offen nt lds
  buffer_load_dwordx4 v221, s[16:19], s30 offen offset:1024 nt lds
  v_mfma_f32_16x16x32_bf16 v[100:103], a[196:199], v[152:155], 0
  v_mfma_f32_16x16x32_bf16 v[104:107], a[200:203], v[152:155], 0
  v_mfma_f32_16x16x32_bf16 v[108:111], a[204:207], v[152:155], 0
  v_mfma_f32_16x16x32_bf16 v[112:115], a[208:211], v[152:155], 0
  v_mfma_f32_16x16x32_bf16 v[116:119], a[212:215], v[152:155], 0
  v_mfma_f32_16x16x32_bf16 v[120:123], a[216:219], v[152:155], 0
  v_mfma_f32_16x16x32_bf16 v[124:127], a[220:223], v[152:155], 0
  v_mfma_f32_16x16x32_bf16 v[196:199], a[224:227], v[152:155], 0
  s_waitcnt lgkmcnt(7)
  v_mfma_f32_16x16x32_bf16 v[128:131], a[160:163], a[64:67], v[160:163]
  s_waitcnt lgkmcnt(6)
  v_mfma_f32_16x16x32_bf16 v[128:131], a[164:167], a[68:71], v[128:131]
  s_waitcnt lgkmcnt(0)
  v_mfma_f32_16x16x32_bf16 v[128:131], a[168:171], a[72:75], v[128:131]
  v_mfma_f32_16x16x32_bf16 v[128:131], a[172:175], a[76:79], v[128:131]
  v_mfma_f32_16x16x32_bf16 v[132:135], a[176:179], a[64:67], v[160:163]
  v_mfma_f32_16x16x32_bf16 v[132:135], a[180:183], a[68:71], v[132:135]
  v_mfma_f32_16x16x32_bf16 v[132:135], a[184:187], a[72:75], v[132:135]
  v_mfma_f32_16x16x32_bf16 v[132:135], a[188:191], a[76:79], v[132:135]
  v_mfma_f32_16x16x32_bf16 v[136:139], a[160:163], a[80:83], v[164:167]
  v_mfma_f32_16x16x32_bf16 v[136:139], a[164:167], a[84:87], v[136:139]
  v_mfma_f32_16x16x32_bf16 v[136:139], a[168:171], a[88:91], v[136:139]
  s_nop 0
  v_exp_f32 v128, v128
  v_mfma_f32_16x16x32_bf16 v[136:139], a[172:175], a[92:95], v[136:139]
  v_exp_f32 v129, v129
  v_mfma_f32_16x16x32_bf16 v[140:143], a[176:179], a[80:83], v[164:167]
  v_exp_f32 v130, v130
  v_mfma_f32_16x16x32_bf16 v[140:143], a[180:183], a[84:87], v[140:143]
  v_exp_f32 v131, v131
  v_mfma_f32_16x16x32_bf16 v[140:143], a[184:187], a[88:91], v[140:143]
  v_exp_f32 v132, v132
  v_mfma_f32_16x16x32_bf16 v[140:143], a[188:191], a[92:95], v[140:143]
  v_exp_f32 v133, v133
  v_exp_f32 v134, v134
  v_exp_f32 v135, v135
L_GO:
  v_mfma_f32_16x16x32_bf16 v[144:147], a[160:163], a[96:99], v[168:171]
  v_exp_f32 v136, v136
  v_lshlrev_b32 v253, 4, v224
  v_mfma_f32_16x16x32_bf16 v[144:147], a[164:167], a[100:103], v[144:147]
  v_cvt_pk_bf16_f32 v128, v128, v129
  v_cvt_pk_bf16_f32 v129, v130, v131
  v_mfma_f32_16x16x32_bf16 v[144:147], a[168:171], a[104:107], v[144:147]
  v_exp_f32 v137, v137
  v_mfma_f32_16x16x32_bf16 v[144:147], a[172:175], a[108:111], v[144:147]
  v_cvt_pk_bf16_f32 v130, v132, v133
  v_cvt_pk_bf16_f32 v131, v134, v135
  v_mfma_f32_16x16x32_bf16 v[148:151], a[176:179], a[96:99], v[168:171]
  v_exp_f32 v138, v138
  v_mfma_f32_16x16x32_bf16 v[148:151], a[180:183], a[100:103], v[148:151]
  s_waitcnt vmcnt(10)
  s_barrier
  v_mfma_f32_16x16x32_bf16 v[148:151], a[184:187], a[104:107], v[148:151]
  v_exp_f32 v139, v139
  v_mfma_f32_16x16x32_bf16 v[148:151], a[188:191], a[108:111], v[148:151]
  ds_read_b64_tr_b16 a[192:193], v211 offset:24576
  ds_read_b64_tr_b16 a[194:195], v211 offset:28672
  v_mfma_f32_16x16x32_bf16 v[152:155], a[160:163], a[112:115], v[172:175]
  v_exp_f32 v140, v140
  v_mfma_f32_16x16x32_bf16 v[152:155], a[164:167], a[116:119], v[152:155]
  ds_read_b64_tr_b16 a[196:197], v214 offset:24576
  ds_read_b64_tr_b16 a[198:199], v214 offset:28672
  v_mfma_f32_16x16x32_bf16 v[152:155], a[168:171], a[120:123], v[152:155]
  v_exp_f32 v141, v141
  v_mfma_f32_16x16x32_bf16 v[152:155], a[172:175], a[124:127], v[152:155]
  ds_read_b64_tr_b16 a[200:201], v211 offset:24832
  ds_read_b64_tr_b16 a[202:203], v211 offset:28928
  v_mfma_f32_16x16x32_bf16 v[156:159], a[176:179], a[112:115], v[172:175]
  v_exp_f32 v142, v142
  v_mfma_f32_16x16x32_bf16 v[156:159], a[180:183], a[116:119], v[156:159]
  ds_read_b64_tr_b16 a[204:205], v214 offset:24832
  ds_read_b64_tr_b16 a[206:207], v214 offset:28928
  v_mfma_f32_16x16x32_bf16 v[156:159], a[184:187], a[120:123], v[156:159]
  v_exp_f32 v143, v143
  v_mfma_f32_16x16x32_bf16 v[156:159], a[188:191], a[124:127], v[156:159]
  s_waitcnt lgkmcnt(6)
  ds_read_b64_tr_b16 a[208:209], v211 offset:25088
  ds_read_b64_tr_b16 a[210:211], v211 offset:29184
  ds_read_b64_tr_b16 a[212:213], v214 offset:25088
  v_mfma_f32_16x16x32_bf16 v[0:3], a[192:195], v[128:131], v[0:3]
  s_waitcnt lgkmcnt(7)
  ds_read_b64_tr_b16 a[214:215], v214 offset:29184
  v_exp_f32 v144, v144
  v_mfma_f32_16x16x32_bf16 v[4:7], a[196:199], v[128:131], v[4:7]
  s_waitcnt lgkmcnt(6)
  s_waitcnt vmcnt(6)
  s_barrier
  ds_read_b64_tr_b16 a[216:217], v211 offset:25344
  v_mfma_f32_16x16x32_bf16 v[8:11], a[200:203], v[128:131], v[8:11]
  s_waitcnt lgkmcnt(5)
  ds_read_b64_tr_b16 a[218:219], v211 offset:29440
  v_exp_f32 v145, v145
  v_mfma_f32_16x16x32_bf16 v[12:15], a[204:207], v[128:131], v[12:15]
  s_waitcnt lgkmcnt(4)
  ds_read_b64_tr_b16 a[220:221], v214 offset:25344
  ds_read_b64_tr_b16 a[222:223], v214 offset:29440
  ds_read_b128 a[160:163], v208 offset:32768
  v_mfma_f32_16x16x32_bf16 v[16:19], a[208:211], v[128:131], v[16:19]
  s_waitcnt lgkmcnt(5)
  ds_read_b128 a[164:167], v208 offset:33024
  v_exp_f32 v146, v146
  v_mfma_f32_16x16x32_bf16 v[20:23], a[212:215], v[128:131], v[20:23]
  s_waitcnt lgkmcnt(4)
  v_cvt_pk_bf16_f32 v136, v136, v137
  v_cvt_pk_bf16_f32 v137, v138, v139
TP4:
  s_cbranch_execz L_TRET
  v_mfma_f32_16x16x32_bf16 v[24:27], a[216:219], v[128:131], v[24:27]
  s_waitcnt lgkmcnt(2)
  v_exp_f32 v147, v147
  v_mfma_f32_16x16x32_bf16 v[28:31], a[220:223], v[128:131], v[28:31]
  v_cvt_pk_bf16_f32 v138, v140, v141
  v_cvt_pk_bf16_f32 v139, v142, v143
  v_mfma_f32_16x16x32_bf16 v[184:187], a[224:227], v[128:131], v[184:187]
  v_exp_f32 v148, v148
  v_mfma_f32_16x16x32_bf16 v[32:35], a[192:195], v[136:139], v[32:35]
  ds_read_b128 a[168:171], v208 offset:33280
  ds_read_b128 a[172:175], v208 offset:33536
  ds_read_b128 a[176:179], v208 offset:36864
  v_mfma_f32_16x16x32_bf16 v[36:39], a[196:199], v[136:139], v[36:39]
  ds_read_b128 a[180:183], v208 offset:37120
  v_exp_f32 v149, v149
  v_mfma_f32_16x16x32_bf16 v[40:43], a[200:203], v[136:139], v[40:43]
  ds_read_b128 a[184:187], v208 offset:37376
  ds_read_b128 a[188:191], v208 offset:37632
  v_mfma_f32_16x16x32_bf16 v[44:47], a[204:207], v[136:139], v[44:47]
  v_exp_f32 v150, v150
  v_mfma_f32_16x16x32_bf16 v[48:51], a[208:211], v[136:139], v[48:51]
  s_add_u32 m0, s29, 73728
  v_mfma_f32_16x16x32_bf16 v[52:55], a[212:215], v[136:139], v[52:55]
  v_exp_f32 v151, v151
  v_mfma_f32_16x16x32_bf16 v[56:59], a[216:219], v[136:139], v[56:59]
  buffer_load_dwordx4 v222, s[20:23], s68 offen nt lds
  v_mfma_f32_16x16x32_bf16 v[60:63], a[220:223], v[136:139], v[60:63]
  v_mfma_f32_16x16x32_bf16 v[188:191], a[224:227], v[136:139], v[188:191]
  s_waitcnt lgkmcnt(6)
  buffer_load_dwordx4 v223, s[20:23], s68 offen offset:1024 nt lds
  v_mfma_f32_16x16x32_bf16 v[128:131], a[160:163], a[64:67], v[160:163]
  v_exp_f32 v152, v152
  v_mfma_f32_16x16x32_bf16 v[128:131], a[164:167], a[68:71], v[128:131]
  s_waitcnt lgkmcnt(3)
  v_cvt_pk_bf16_f32 v144, v144, v145
  v_cvt_pk_bf16_f32 v145, v146, v147
  v_mfma_f32_16x16x32_bf16 v[128:131], a[168:171], a[72:75], v[128:131]
  v_exp_f32 v153, v153
  v_mfma_f32_16x16x32_bf16 v[128:131], a[172:175], a[76:79], v[128:131]
  v_cvt_pk_bf16_f32 v146, v148, v149
  v_cvt_pk_bf16_f32 v147, v150, v151
  v_mfma_f32_16x16x32_bf16 v[132:135], a[176:179], a[64:67], v[160:163]
  s_waitcnt lgkmcnt(0)
  v_exp_f32 v154, v154
  v_mfma_f32_16x16x32_bf16 v[132:135], a[180:183], a[68:71], v[132:135]
  s_add_u32 m0, s29, 155648
  v_cvt_pk_bf16_f32 v152, v152, v153
  v_mfma_f32_16x16x32_bf16 v[132:135], a[184:187], a[72:75], v[132:135]
  v_exp_f32 v155, v155
  v_mfma_f32_16x16x32_bf16 v[132:135], a[188:191], a[76:79], v[132:135]
  v_cvt_pk_bf16_f32 v153, v154, v155
  v_mfma_f32_16x16x32_bf16 v[136:139], a[160:163], a[80:83], v[164:167]
  v_exp_f32 v156, v156
  v_mfma_f32_16x16x32_bf16 v[136:139], a[164:167], a[84:87], v[136:139]
  buffer_load_dwordx4 v220, s[12:15], s72 offen nt lds
  v_mfma_f32_16x16x32_bf16 v[136:139], a[168:171], a[88:91], v[136:139]
  v_exp_f32 v157, v157
  v_mfma_f32_16x16x32_bf16 v[136:139], a[172:175], a[92:95], v[136:139]
  v_cvt_pk_bf16_f32 v154, v156, v157
  v_mfma_f32_16x16x32_bf16 v[140:143], a[176:179], a[80:83], v[164:167]
  v_exp_f32 v158, v158
  v_mfma_f32_16x16x32_bf16 v[140:143], a[180:183], a[84:87], v[140:143]
  buffer_load_dwordx4 v221, s[12:15], s72 offen offset:1024 nt lds
  v_mfma_f32_16x16x32_bf16 v[140:143], a[184:187], a[88:91], v[140:143]
  v_exp_f32 v159, v159
  v_mfma_f32_16x16x32_bf16 v[140:143], a[188:191], a[92:95], v[140:143]
  s_add_u32 m0, s29, 81920
  v_cvt_pk_bf16_f32 v155, v158, v159
  v_mfma_f32_16x16x32_bf16 v[64:67], a[192:195], v[144:147], v[64:67]
  v_exp_f32 v128, v128
  v_mfma_f32_16x16x32_bf16 v[68:71], a[196:199], v[144:147], v[68:71]
  buffer_load_dwordx4 v220, s[16:19], s69 offen nt lds
  v_mfma_f32_16x16x32_bf16 v[72:75], a[200:203], v[144:147], v[72:75]
  v_exp_f32 v129, v129
  v_mfma_f32_16x16x32_bf16 v[76:79], a[204:207], v[144:147], v[76:79]
  buffer_load_dwordx4 v221, s[16:19], s69 offen offset:1024 nt lds
  v_mfma_f32_16x16x32_bf16 v[80:83], a[208:211], v[144:147], v[80:83]
  v_exp_f32 v130, v130
  v_mfma_f32_16x16x32_bf16 v[84:87], a[212:215], v[144:147], v[84:87]
  v_mfma_f32_16x16x32_bf16 v[88:91], a[216:219], v[144:147], v[88:91]
  v_exp_f32 v131, v131
  v_mfma_f32_16x16x32_bf16 v[92:95], a[220:223], v[144:147], v[92:95]
  v_mfma_f32_16x16x32_bf16 v[192:195], a[224:227], v[144:147], v[192:195]
  v_exp_f32 v132, v132
  v_mfma_f32_16x16x32_bf16 v[96:99], a[192:195], v[152:155], v[96:99]
  v_mfma_f32_16x16x32_bf16 v[100:103], a[196:199], v[152:155], v[100:103]
  v_exp_f32 v133, v133
  v_mfma_f32_16x16x32_bf16 v[104:107], a[200:203], v[152:155], v[104:107]
  ds_read_b64_tr_b16 a[192:193], v211 offset:40960
  ds_read_b64_tr_b16 a[194:195], v211 offset:45056
  v_mfma_f32_16x16x32_bf16 v[108:111], a[204:207], v[152:155], v[108:111]
  v_exp_f32 v134, v134
  v_mfma_f32_16x16x32_bf16 v[112:115], a[208:211], v[152:155], v[112:115]
  ds_read_b64_tr_b16 a[196:197], v214 offset:40960
  ds_read_b64_tr_b16 a[198:199], v214 offset:45056
  v_mfma_f32_16x16x32_bf16 v[116:119], a[212:215], v[152:155], v[116:119]
  v_exp_f32 v135, v135
  v_mfma_f32_16x16x32_bf16 v[120:123], a[216:219], v[152:155], v[120:123]
  ds_read_b64_tr_b16 a[200:201], v211 offset:41216
  ds_read_b64_tr_b16 a[202:203], v211 offset:45312
  v_mfma_f32_16x16x32_bf16 v[124:127], a[220:223], v[152:155], v[124:127]
  ds_read_b64_tr_b16 a[204:205], v214 offset:41216
  ds_read_b64_tr_b16 a[206:207], v214 offset:45312
  v_mfma_f32_16x16x32_bf16 v[196:199], a[224:227], v[152:155], v[196:199]
  v_mfma_f32_16x16x32_bf16 v[144:147], a[160:163], a[96:99], v[168:171]
  v_exp_f32 v136, v136
  v_mfma_f32_16x16x32_bf16 v[144:147], a[164:167], a[100:103], v[144:147]
  ds_read_b64_tr_b16 a[208:209], v211 offset:41472
  ds_read_b64_tr_b16 a[210:211], v211 offset:45568
  v_mfma_f32_16x16x32_bf16 v[144:147], a[168:171], a[104:107], v[144:147]
  v_exp_f32 v137, v137
  v_mfma_f32_16x16x32_bf16 v[144:147], a[172:175], a[108:111], v[144:147]
  ds_read_b64_tr_b16 a[212:213], v214 offset:41472
  ds_read_b64_tr_b16 a[214:215], v214 offset:45568
  v_mfma_f32_16x16x32_bf16 v[148:151], a[176:179], a[96:99], v[168:171]
  v_exp_f32 v138, v138
  v_mfma_f32_16x16x32_bf16 v[148:151], a[180:183], a[100:103], v[148:151]
  ds_read_b64_tr_b16 a[216:217], v211 offset:41728
  ds_read_b64_tr_b16 a[218:219], v211 offset:45824
  v_mfma_f32_16x16x32_bf16 v[148:151], a[184:187], a[104:107], v[148:151]
  v_exp_f32 v139, v139
  v_mfma_f32_16x16x32_bf16 v[148:151], a[188:191], a[108:111], v[148:151]
  ds_read_b64_tr_b16 a[220:221], v214 offset:41728
  ds_read_b64_tr_b16 a[222:223], v214 offset:45824
  v_mfma_f32_16x16x32_bf16 v[152:155], a[160:163], a[112:115], v[172:175]
  v_exp_f32 v140, v140
  v_mfma_f32_16x16x32_bf16 v[152:155], a[164:167], a[116:119], v[152:155]
  v_cvt_pk_bf16_f32 v128, v128, v129
  v_cvt_pk_bf16_f32 v129, v130, v131
  v_mfma_f32_16x16x32_bf16 v[152:155], a[168:171], a[120:123], v[152:155]
  v_exp_f32 v141, v141
  v_mfma_f32_16x16x32_bf16 v[152:155], a[172:175], a[124:127], v[152:155]
  v_cvt_pk_bf16_f32 v130, v132, v133
  v_cvt_pk_bf16_f32 v131, v134, v135
  v_mfma_f32_16x16x32_bf16 v[156:159], a[176:179], a[112:115], v[172:175]
  v_exp_f32 v142, v142
  v_mfma_f32_16x16x32_bf16 v[156:159], a[180:183], a[116:119], v[156:159]
  v_cvt_pk_bf16_f32 v136, v136, v137
  v_cvt_pk_bf16_f32 v137, v138, v139
  v_mfma_f32_16x16x32_bf16 v[156:159], a[184:187], a[120:123], v[156:159]
  v_exp_f32 v143, v143
  v_mfma_f32_16x16x32_bf16 v[156:159], a[188:191], a[124:127], v[156:159]
  s_waitcnt lgkmcnt(2)
  v_cvt_pk_bf16_f32 v138, v140, v141
  v_cvt_pk_bf16_f32 v139, v142, v143
TP5:
  s_cbranch_execz L_TRET
  v_mfma_f32_16x16x32_bf16 v[0:3], a[192:195], v[128:131], v[0:3]
  v_exp_f32 v144, v144
  v_mfma_f32_16x16x32_bf16 v[4:7], a[196:199], v[128:131], v[4:7]
  s_waitcnt vmcnt(8)
  s_barrier
  v_mfma_f32_16x16x32_bf16 v[8:11], a[200:203], v[128:131], v[8:11]
  v_exp_f32 v145, v145
  v_mfma_f32_16x16x32_bf16 v[12:15], a[204:207], v[128:131], v[12:15]
  ds_read_b128 a[160:163], v208 offset:49152
  ds_read_b128 a[164:167], v208 offset:49408
  v_mfma_f32_16x16x32_bf16 v[16:19], a[208:211], v[128:131], v[16:19]
  v_exp_f32 v146, v146
  v_mfma_f32_16x16x32_bf16 v[20:23], a[212:215], v[128:131], v[20:23]
  ds_read_b128 a[168:171], v208 offset:49664
  ds_read_b128 a[172:175], v208 offset:49920
  v_mfma_f32_16x16x32_bf16 v[24:27], a[216:219], v[128:131], v[24:27]
  s_waitcnt lgkmcnt(4)
  v_exp_f32 v147, v147
  v_mfma_f32_16x16x32_bf16 v[28:31], a[220:223], v[128:131], v[28:31]
  ds_read_b128 a[176:179], v208 offset:53248
  ds_read_b128 a[180:183], v208 offset:53504
  v_mfma_f32_16x16x32_bf16 v[184:187], a[224:227], v[128:131], v[184:187]
  v_exp_f32 v148, v148
  v_mfma_f32_16x16x32_bf16 v[32:35], a[192:195], v[136:139], v[32:35]
  ds_read_b128 a[184:187], v208 offset:53760
  ds_read_b128 a[188:191], v208 offset:54016
  v_mfma_f32_16x16x32_bf16 v[36:39], a[196:199], v[136:139], v[36:39]
  v_exp_f32 v149, v149
  v_mfma_f32_16x16x32_bf16 v[40:43], a[200:203], v[136:139], v[40:43]
  v_mfma_f32_16x16x32_bf16 v[44:47], a[204:207], v[136:139], v[44:47]
  v_exp_f32 v150, v150
  v_mfma_f32_16x16x32_bf16 v[48:51], a[208:211], v[136:139], v[48:51]
  v_mfma_f32_16x16x32_bf16 v[52:55], a[212:215], v[136:139], v[52:55]
  v_exp_f32 v151, v151
  v_mfma_f32_16x16x32_bf16 v[56:59], a[216:219], v[136:139], v[56:59]
  v_mfma_f32_16x16x32_bf16 v[60:63], a[220:223], v[136:139], v[60:63]
  v_mfma_f32_16x16x32_bf16 v[188:191], a[224:227], v[136:139], v[188:191]
  s_waitcnt lgkmcnt(2)
  v_mfma_f32_16x16x32_bf16 v[128:131], a[160:163], a[64:67], v[160:163]
  s_waitcnt vmcnt(2)
  v_exp_f32 v152, v152
  v_mfma_f32_16x16x32_bf16 v[128:131], a[164:167], a[68:71], v[128:131]
  ds_read_b128 v[234:237], v250
  v_cvt_pk_bf16_f32 v144, v144, v145
  v_cvt_pk_bf16_f32 v145, v146, v147
  v_mfma_f32_16x16x32_bf16 v[128:131], a[168:171], a[72:75], v[128:131]
  ds_read_b128 v[238:241], v250 offset:1024
  v_exp_f32 v153, v153
  v_mfma_f32_16x16x32_bf16 v[128:131], a[172:175], a[76:79], v[128:131]
  v_cvt_pk_bf16_f32 v146, v148, v149
  v_cvt_pk_bf16_f32 v147, v150, v151
  v_mfma_f32_16x16x32_bf16 v[132:135], a[176:179], a[64:67], v[160:163]
  v_exp_f32 v154, v154
  v_mfma_f32_16x16x32_bf16 v[132:135], a[180:183], a[68:71], v[132:135]
  s_waitcnt lgkmcnt(2)
  s_add_u32 m0, s29, 90112
  v_cvt_pk_bf16_f32 v152, v152, v153
  v_mfma_f32_16x16x32_bf16 v[132:135], a[184:187], a[72:75], v[132:135]
  v_exp_f32 v155, v155
  v_mfma_f32_16x16x32_bf16 v[132:135], a[188:191], a[76:79], v[132:135]
  v_cvt_pk_bf16_f32 v153, v154, v155
  v_mfma_f32_16x16x32_bf16 v[136:139], a[160:163], a[80:83], v[164:167]
  v_exp_f32 v156, v156
  v_mfma_f32_16x16x32_bf16 v[136:139], a[164:167], a[84:87], v[136:139]
  buffer_load_dwordx4 v222, s[20:23], s69 offen nt lds
  s_waitcnt lgkmcnt(1)
  v_lshlrev_b32 v242, 16, v234
  v_mfma_f32_16x16x32_bf16 v[136:139], a[168:171], a[88:91], v[136:139]
  v_exp_f32 v157, v157
  v_lshlrev_b32 v244, 16, v235
  v_mfma_f32_16x16x32_bf16 v[136:139], a[172:175], a[92:95], v[136:139]
  v_cvt_pk_bf16_f32 v154, v156, v157
  v_lshlrev_b32 v246, 16, v236
  v_lshlrev_b32 v248, 16, v237
  v_mfma_f32_16x16x32_bf16 v[140:143], a[176:179], a[80:83], v[164:167]
  v_exp_f32 v158, v158
  v_and_b32 v243, s36, v234
  v_mfma_f32_16x16x32_bf16 v[140:143], a[180:183], a[84:87], v[140:143]
  buffer_load_dwordx4 v223, s[20:23], s69 offen offset:1024 nt lds
  v_and_b32 v245, s36, v235
  v_mfma_f32_16x16x32_bf16 v[140:143], a[184:187], a[88:91], v[140:143]
  v_exp_f32 v159, v159
  v_and_b32 v247, s36, v236
  v_mfma_f32_16x16x32_bf16 v[140:143], a[188:191], a[92:95], v[140:143]
  s_add_u32 m0, s29, 98304
  v_cvt_pk_bf16_f32 v155, v158, v159
  v_and_b32 v249, s36, v237
  v_mfma_f32_16x16x32_bf16 v[64:67], a[192:195], v[144:147], v[64:67]
  v_exp_f32 v128, v128
  v_mul_f32 v242, s34, v242
  v_mfma_f32_16x16x32_bf16 v[68:71], a[196:199], v[144:147], v[68:71]
  buffer_load_dwordx4 v220, s[16:19], s70 offen nt lds
  v_mul_f32 v243, s34, v243
  v_mfma_f32_16x16x32_bf16 v[72:75], a[200:203], v[144:147], v[72:75]
  v_exp_f32 v129, v129
  v_mul_f32 v244, s34, v244
  v_mfma_f32_16x16x32_bf16 v[76:79], a[204:207], v[144:147], v[76:79]
  buffer_load_dwordx4 v221, s[16:19], s70 offen offset:1024 nt lds
  v_mul_f32 v245, s34, v245
  v_mfma_f32_16x16x32_bf16 v[80:83], a[208:211], v[144:147], v[80:83]
  v_exp_f32 v130, v130
  v_mul_f32 v246, s34, v246
  v_mfma_f32_16x16x32_bf16 v[84:87], a[212:215], v[144:147], v[84:87]
  v_mul_f32 v247, s34, v247
  v_mul_f32 v248, s34, v248
  v_mul_f32 v249, s34, v249
  v_mfma_f32_16x16x32_bf16 v[88:91], a[216:219], v[144:147], v[88:91]
  v_exp_f32 v131, v131
  v_cvt_pk_bf16_f32 v234, v242, v243
  v_mfma_f32_16x16x32_bf16 v[92:95], a[220:223], v[144:147], v[92:95]
  v_cvt_pk_bf16_f32 v235, v244, v245
  v_cvt_pk_bf16_f32 v236, v246, v247
  v_cvt_pk_bf16_f32 v237, v248, v249
  v_mfma_f32_16x16x32_bf16 v[192:195], a[224:227], v[144:147], v[192:195]
  ds_write_b128 v250, v[234:237]
  v_exp_f32 v132, v132
  v_mfma_f32_16x16x32_bf16 v[96:99], a[192:195], v[152:155], v[96:99]
  s_waitcnt lgkmcnt(1)
  v_lshlrev_b32 v242, 16, v238
  v_lshlrev_b32 v244, 16, v239
  v_lshlrev_b32 v246, 16, v240
  v_mfma_f32_16x16x32_bf16 v[100:103], a[196:199], v[152:155], v[100:103]
  v_exp_f32 v133, v133
  v_lshlrev_b32 v248, 16, v241
  v_mfma_f32_16x16x32_bf16 v[104:107], a[200:203], v[152:155], v[104:107]
  ds_read_b64_tr_b16 a[192:193], v211 offset:57344
  ds_read_b64_tr_b16 a[194:195], v211 offset:61440
  v_and_b32 v243, s36, v238
  v_mfma_f32_16x16x32_bf16 v[108:111], a[204:207], v[152:155], v[108:111]
  v_exp_f32 v134, v134
  v_and_b32 v245, s36, v239
  v_mfma_f32_16x16x32_bf16 v[112:115], a[208:211], v[152:155], v[112:115]
  ds_read_b64_tr_b16 a[196:197], v214 offset:57344
  ds_read_b64_tr_b16 a[198:199], v214 offset:61440
  v_and_b32 v247, s36, v240
  v_mfma_f32_16x16x32_bf16 v[116:119], a[212:215], v[152:155], v[116:119]
  v_exp_f32 v135, v135
  v_and_b32 v249, s36, v241
  v_mfma_f32_16x16x32_bf16 v[120:123], a[216:219], v[152:155], v[120:123]
  ds_read_b64_tr_b16 a[200:201], v211 offset:57600
  ds_read_b64_tr_b16 a[202:203], v211 offset:61696
  v_mul_f32 v242, s34, v242
  v_mfma_f32_16x16x32_bf16 v[124:127], a[220:223], v[152:155], v[124:127]
  ds_read_b64_tr_b16 a[204:205], v214 offset:57600
  ds_read_b64_tr_b16 a[206:207], v214 offset:61696
  v_mul_f32 v243, s34, v243
  v_mfma_f32_16x16x32_bf16 v[196:199], a[224:227], v[152:155], v[196:199]
  v_mul_f32 v244, s34, v244
  v_mul_f32 v245, s34, v245
  v_mul_f32 v246, s34, v246
  v_mfma_f32_16x16x32_bf16 v[144:147], a[160:163], a[96:99], v[168:171]
  v_exp_f32 v136, v136
  v_mul_f32 v247, s34, v247
  v_mfma_f32_16x16x32_bf16 v[144:147], a[164:167], a[100:103], v[144:147]
  ds_read_b64_tr_b16 a[208:209], v211 offset:57856
  ds_read_b64_tr_b16 a[210:211], v211 offset:61952
  v_mul_f32 v248, s34, v248
  v_mfma_f32_16x16x32_bf16 v[144:147], a[168:171], a[104:107], v[144:147]
  v_exp_f32 v137, v137
  v_mul_f32 v249, s34, v249
TP6:
  s_cbranch_execz L_TRET
  v_mfma_f32_16x16x32_bf16 v[144:147], a[172:175], a[108:111], v[144:147]
  ds_read_b64_tr_b16 a[212:213], v214 offset:57856
  ds_read_b64_tr_b16 a[214:215], v214 offset:61952
  v_cvt_pk_bf16_f32 v238, v242, v243
  v_mfma_f32_16x16x32_bf16 v[148:151], a[176:179], a[96:99], v[168:171]
  v_exp_f32 v138, v138
  v_cvt_pk_bf16_f32 v239, v244, v245
  v_mfma_f32_16x16x32_bf16 v[148:151], a[180:183], a[100:103], v[148:151]
  ds_read_b64_tr_b16 a[216:217], v211 offset:58112
  ds_read_b64_tr_b16 a[218:219], v211 offset:62208
  v_cvt_pk_bf16_f32 v240, v246, v247
  v_mfma_f32_16x16x32_bf16 v[148:151], a[184:187], a[104:107], v[148:151]
  v_exp_f32 v139, v139
  v_cvt_pk_bf16_f32 v241, v248, v249
  v_mfma_f32_16x16x32_bf16 v[148:151], a[188:191], a[108:111], v[148:151]
  s_waitcnt vmcnt(8)
  s_barrier
  ds_write_b128 v250, v[238:241] offset:1024
  v_mfma_f32_16x16x32_bf16 v[152:155], a[160:163], a[112:115], v[172:175]
  v_exp_f32 v140, v140
  v_mfma_f32_16x16x32_bf16 v[152:155], a[164:167], a[116:119], v[152:155]
  ds_read_b64_tr_b16 a[220:221], v214 offset:58112
  ds_read_b64_tr_b16 a[222:223], v214 offset:62208
  v_mfma_f32_16x16x32_bf16 v[152:155], a[168:171], a[120:123], v[152:155]
  v_exp_f32 v141, v141
  v_mfma_f32_16x16x32_bf16 v[152:155], a[172:175], a[124:127], v[152:155]
  v_cvt_pk_bf16_f32 v128, v128, v129
  v_cvt_pk_bf16_f32 v129, v130, v131
  v_mfma_f32_16x16x32_bf16 v[156:159], a[176:179], a[112:115], v[172:175]
  v_exp_f32 v142, v142
  v_mfma_f32_16x16x32_bf16 v[156:159], a[180:183], a[116:119], v[156:159]
  v_cvt_pk_bf16_f32 v130, v132, v133
  v_cvt_pk_bf16_f32 v131, v134, v135
  v_mfma_f32_16x16x32_bf16 v[156:159], a[184:187], a[120:123], v[156:159]
  v_exp_f32 v143, v143
  v_mfma_f32_16x16x32_bf16 v[156:159], a[188:191], a[124:127], v[156:159]
  s_waitcnt lgkmcnt(3)
  v_cvt_pk_bf16_f32 v136, v136, v137
  v_cvt_pk_bf16_f32 v137, v138, v139
  v_mfma_f32_16x16x32_bf16 v[0:3], a[192:195], v[128:131], v[0:3]
  v_exp_f32 v144, v144
  v_mfma_f32_16x16x32_bf16 v[4:7], a[196:199], v[128:131], v[4:7]
  v_cvt_pk_bf16_f32 v138, v140, v141
  v_cvt_pk_bf16_f32 v139, v142, v143
  v_mfma_f32_16x16x32_bf16 v[8:11], a[200:203], v[128:131], v[8:11]
  v_exp_f32 v145, v145
  v_mfma_f32_16x16x32_bf16 v[12:15], a[204:207], v[128:131], v[12:15]
  ds_read_b128 a[160:163], v209
  ds_read_b128 a[164:167], v209 offset:256
  v_mfma_f32_16x16x32_bf16 v[16:19], a[208:211], v[128:131], v[16:19]
  v_exp_f32 v146, v146
  v_mfma_f32_16x16x32_bf16 v[20:23], a[212:215], v[128:131], v[20:23]
  ds_read_b128 a[168:171], v209 offset:512
  ds_read_b128 a[172:175], v209 offset:768
  v_mfma_f32_16x16x32_bf16 v[24:27], a[216:219], v[128:131], v[24:27]
  s_waitcnt lgkmcnt(4)
  v_exp_f32 v147, v147
  v_mfma_f32_16x16x32_bf16 v[28:31], a[220:223], v[128:131], v[28:31]
  ds_read_b128 a[176:179], v209 offset:4096
  ds_read_b128 a[180:183], v209 offset:4352
  v_mfma_f32_16x16x32_bf16 v[184:187], a[224:227], v[128:131], v[184:187]
  v_exp_f32 v148, v148
  v_mfma_f32_16x16x32_bf16 v[32:35], a[192:195], v[136:139], v[32:35]
  ds_read_b128 a[184:187], v209 offset:4608
  ds_read_b128 a[188:191], v209 offset:4864
  v_mfma_f32_16x16x32_bf16 v[36:39], a[196:199], v[136:139], v[36:39]
  v_exp_f32 v149, v149
  v_mfma_f32_16x16x32_bf16 v[40:43], a[200:203], v[136:139], v[40:43]
  v_mfma_f32_16x16x32_bf16 v[44:47], a[204:207], v[136:139], v[44:47]
  v_exp_f32 v150, v150
  v_mfma_f32_16x16x32_bf16 v[48:51], a[208:211], v[136:139], v[48:51]
  v_mfma_f32_16x16x32_bf16 v[52:55], a[212:215], v[136:139], v[52:55]
  v_exp_f32 v151, v151
  v_mfma_f32_16x16x32_bf16 v[56:59], a[216:219], v[136:139], v[56:59]
  v_mfma_f32_16x16x32_bf16 v[60:63], a[220:223], v[136:139], v[60:63]
  v_mfma_f32_16x16x32_bf16 v[188:191], a[224:227], v[136:139], v[188:191]
  s_waitcnt lgkmcnt(2)
  v_mfma_f32_16x16x32_bf16 v[128:131], a[160:163], a[64:67], v[160:163]
  v_exp_f32 v152, v152
  v_mfma_f32_16x16x32_bf16 v[128:131], a[164:167], a[68:71], v[128:131]
  v_cvt_pk_bf16_f32 v144, v144, v145
  v_cvt_pk_bf16_f32 v145, v146, v147
  v_mfma_f32_16x16x32_bf16 v[128:131], a[168:171], a[72:75], v[128:131]
  v_exp_f32 v153, v153
  v_mfma_f32_16x16x32_bf16 v[128:131], a[172:175], a[76:79], v[128:131]
  v_cvt_pk_bf16_f32 v146, v148, v149
  v_cvt_pk_bf16_f32 v147, v150, v151
  v_mfma_f32_16x16x32_bf16 v[132:135], a[176:179], a[64:67], v[160:163]
  v_exp_f32 v154, v154
  v_mfma_f32_16x16x32_bf16 v[132:135], a[180:183], a[68:71], v[132:135]
  s_waitcnt lgkmcnt(0)
  s_add_u32 m0, s29, 106496
  v_cvt_pk_bf16_f32 v152, v152, v153
  v_mfma_f32_16x16x32_bf16 v[132:135], a[184:187], a[72:75], v[132:135]
  v_exp_f32 v155, v155
  v_mfma_f32_16x16x32_bf16 v[132:135], a[188:191], a[76:79], v[132:135]
  s_barrier
  v_mfma_f32_16x16x32_bf16 v[136:139], a[160:163], a[80:83], v[164:167]
  ds_read_b128 a[128:131], v254
  v_exp_f32 v156, v156
  v_mfma_f32_16x16x32_bf16 v[136:139], a[164:167], a[84:87], v[136:139]
  ds_read_b128 a[132:135], v254 offset:256
  ds_read_b128 a[136:139], v254 offset:512
  v_cvt_pk_bf16_f32 v153, v154, v155
  v_mfma_f32_16x16x32_bf16 v[136:139], a[168:171], a[88:91], v[136:139]
  ds_read_b128 a[140:143], v254 offset:768
  v_exp_f32 v157, v157
  v_mfma_f32_16x16x32_bf16 v[136:139], a[172:175], a[92:95], v[136:139]
  ds_read_b128 a[144:147], v254 offset:4096
  ds_read_b128 a[148:151], v254 offset:4352
  v_cvt_pk_bf16_f32 v154, v156, v157
  v_mfma_f32_16x16x32_bf16 v[140:143], a[176:179], a[80:83], v[164:167]
  ds_read_b128 a[152:155], v254 offset:4608
  v_exp_f32 v158, v158
  v_mfma_f32_16x16x32_bf16 v[140:143], a[180:183], a[84:87], v[140:143]
  buffer_load_dwordx4 v222, s[20:23], s70 offen nt lds
  ds_read_b128 a[156:159], v254 offset:4864
  v_mfma_f32_16x16x32_bf16 v[140:143], a[184:187], a[88:91], v[140:143]
  v_exp_f32 v159, v159
  v_mfma_f32_16x16x32_bf16 v[140:143], a[188:191], a[92:95], v[140:143]
  v_cvt_pk_bf16_f32 v155, v158, v159
  v_mfma_f32_16x16x32_bf16 v[64:67], a[192:195], v[144:147], v[64:67]
  v_exp_f32 v128, v128
  v_mfma_f32_16x16x32_bf16 v[68:71], a[196:199], v[144:147], v[68:71]
  buffer_load_dwordx4 v223, s[20:23], s70 offen offset:1024 nt lds
  v_mfma_f32_16x16x32_bf16 v[72:75], a[200:203], v[144:147], v[72:75]
  v_exp_f32 v129, v129
  v_mfma_f32_16x16x32_bf16 v[76:79], a[204:207], v[144:147], v[76:79]
  s_add_u32 m0, s29, 114688
  v_mfma_f32_16x16x32_bf16 v[80:83], a[208:211], v[144:147], v[80:83]
  v_exp_f32 v130, v130
  v_mfma_f32_16x16x32_bf16 v[84:87], a[212:215], v[144:147], v[84:87]
  buffer_load_dwordx4 v220, s[16:19], s71 offen nt lds
  v_mfma_f32_16x16x32_bf16 v[88:91], a[216:219], v[144:147], v[88:91]
  v_exp_f32 v131, v131
  v_mfma_f32_16x16x32_bf16 v[92:95], a[220:223], v[144:147], v[92:95]
  buffer_load_dwordx4 v221, s[16:19], s71 offen offset:1024 nt lds
  v_mfma_f32_16x16x32_bf16 v[192:195], a[224:227], v[144:147], v[192:195]
  v_exp_f32 v132, v132
  v_mfma_f32_16x16x32_bf16 v[96:99], a[192:195], v[152:155], v[96:99]
  v_mfma_f32_16x16x32_bf16 v[100:103], a[196:199], v[152:155], v[100:103]
  v_exp_f32 v133, v133
  v_mfma_f32_16x16x32_bf16 v[104:107], a[200:203], v[152:155], v[104:107]
  ds_read_b64_tr_b16 a[192:193], v212 offset:8192
  ds_read_b64_tr_b16 a[194:195], v212 offset:12288
TP7:
  s_cbranch_execz L_TRET
  v_mfma_f32_16x16x32_bf16 v[108:111], a[204:207], v[152:155], v[108:111]
  v_exp_f32 v134, v134
  v_mfma_f32_16x16x32_bf16 v[112:115], a[208:211], v[152:155], v[112:115]
  ds_read_b64_tr_b16 a[196:197], v215 offset:8192
  ds_read_b64_tr_b16 a[198:199], v215 offset:12288
  v_mfma_f32_16x16x32_bf16 v[116:119], a[212:215], v[152:155], v[116:119]
  v_exp_f32 v135, v135
  v_mfma_f32_16x16x32_bf16 v[120:123], a[216:219], v[152:155], v[120:123]
  ds_read_b64_tr_b16 a[200:201], v212 offset:8448
  ds_read_b64_tr_b16 a[202:203], v212 offset:12544
  v_mfma_f32_16x16x32_bf16 v[124:127], a[220:223], v[152:155], v[124:127]
  ds_read_b64_tr_b16 a[204:205], v215 offset:8448
  ds_read_b64_tr_b16 a[206:207], v215 offset:12544
  v_mfma_f32_16x16x32_bf16 v[196:199], a[224:227], v[152:155], v[196:199]
  v_mfma_f32_16x16x32_bf16 v[144:147], a[160:163], a[96:99], v[168:171]
  v_exp_f32 v136, v136
  v_mfma_f32_16x16x32_bf16 v[144:147], a[164:167], a[100:103], v[144:147]
  ds_read_b64_tr_b16 a[208:209], v212 offset:8704
  ds_read_b64_tr_b16 a[210:211], v212 offset:12800
  v_mfma_f32_16x16x32_bf16 v[144:147], a[168:171], a[104:107], v[144:147]
  v_exp_f32 v137, v137
  v_mfma_f32_16x16x32_bf16 v[144:147], a[172:175], a[108:111], v[144:147]
  ds_read_b64_tr_b16 a[212:213], v215 offset:8704
  ds_read_b64_tr_b16 a[214:215], v215 offset:12800
  v_mfma_f32_16x16x32_bf16 v[148:151], a[176:179], a[96:99], v[168:171]
  v_exp_f32 v138, v138
  v_mfma_f32_16x16x32_bf16 v[148:151], a[180:183], a[100:103], v[148:151]
  ds_read_b64_tr_b16 a[216:217], v212 offset:8960
  ds_read_b64_tr_b16 a[218:219], v212 offset:13056
  v_mfma_f32_16x16x32_bf16 v[148:151], a[184:187], a[104:107], v[148:151]
  v_exp_f32 v139, v139
  v_mfma_f32_16x16x32_bf16 v[148:151], a[188:191], a[108:111], v[148:151]
  ds_read_b64_tr_b16 a[220:221], v215 offset:8960
  ds_read_b64_tr_b16 a[222:223], v215 offset:13056
  v_mfma_f32_16x16x32_bf16 v[152:155], a[160:163], a[112:115], v[172:175]
  v_exp_f32 v140, v140
  v_mfma_f32_16x16x32_bf16 v[152:155], a[164:167], a[116:119], v[152:155]
  v_cvt_pk_bf16_f32 v128, v128, v129
  v_cvt_pk_bf16_f32 v129, v130, v131
  v_mfma_f32_16x16x32_bf16 v[152:155], a[168:171], a[120:123], v[152:155]
  v_exp_f32 v141, v141
  v_mfma_f32_16x16x32_bf16 v[152:155], a[172:175], a[124:127], v[152:155]
  v_cvt_pk_bf16_f32 v130, v132, v133
  v_cvt_pk_bf16_f32 v131, v134, v135
  v_mfma_f32_16x16x32_bf16 v[156:159], a[176:179], a[112:115], v[172:175]
  v_exp_f32 v142, v142
  v_mfma_f32_16x16x32_bf16 v[156:159], a[180:183], a[116:119], v[156:159]
  v_cvt_pk_bf16_f32 v136, v136, v137
  v_cvt_pk_bf16_f32 v137, v138, v139
  v_mfma_f32_16x16x32_bf16 v[156:159], a[184:187], a[120:123], v[156:159]
  v_exp_f32 v143, v143
  v_mfma_f32_16x16x32_bf16 v[156:159], a[188:191], a[124:127], v[156:159]
  s_waitcnt lgkmcnt(2)
  v_cvt_pk_bf16_f32 v138, v140, v141
  v_cvt_pk_bf16_f32 v139, v142, v143
  v_mfma_f32_16x16x32_bf16 v[0:3], a[192:195], v[128:131], v[0:3]
  v_exp_f32 v144, v144
  v_mfma_f32_16x16x32_bf16 v[4:7], a[196:199], v[128:131], v[4:7]
  ds_read_b128 a[160:163], v217
  ds_read_b128 a[164:167], v217 offset:256
  v_mfma_f32_16x16x32_bf16 v[8:11], a[200:203], v[128:131], v[8:11]
  v_exp_f32 v145, v145
  v_mfma_f32_16x16x32_bf16 v[12:15], a[204:207], v[128:131], v[12:15]
  ds_read_b128 a[168:171], v217 offset:512
  ds_read_b128 a[172:175], v217 offset:768
  v_mfma_f32_16x16x32_bf16 v[16:19], a[208:211], v[128:131], v[16:19]
  v_exp_f32 v146, v146
  v_mfma_f32_16x16x32_bf16 v[20:23], a[212:215], v[128:131], v[20:23]
  ds_read_b128 a[176:179], v217 offset:4096
  ds_read_b128 a[180:183], v217 offset:4352
  v_mfma_f32_16x16x32_bf16 v[24:27], a[216:219], v[128:131], v[24:27]
  s_waitcnt lgkmcnt(6)
  v_exp_f32 v147, v147
  v_mfma_f32_16x16x32_bf16 v[28:31], a[220:223], v[128:131], v[28:31]
  ds_read_b128 a[184:187], v217 offset:4608
  ds_read_b128 a[188:191], v217 offset:4864
  v_mfma_f32_16x16x32_bf16 v[184:187], a[224:227], v[128:131], v[184:187]
  v_exp_f32 v148, v148
  v_mfma_f32_16x16x32_bf16 v[32:35], a[192:195], v[136:139], v[32:35]
  s_add_u32 m0, s29, 122880
  v_mfma_f32_16x16x32_bf16 v[36:39], a[196:199], v[136:139], v[36:39]
  v_exp_f32 v149, v149
  v_mfma_f32_16x16x32_bf16 v[40:43], a[200:203], v[136:139], v[40:43]
  buffer_load_dwordx4 v222, s[20:23], s71 offen nt lds
  v_mfma_f32_16x16x32_bf16 v[44:47], a[204:207], v[136:139], v[44:47]
  v_exp_f32 v150, v150
  v_mfma_f32_16x16x32_bf16 v[48:51], a[208:211], v[136:139], v[48:51]
  buffer_load_dwordx4 v223, s[20:23], s71 offen offset:1024 nt lds
  v_mfma_f32_16x16x32_bf16 v[52:55], a[212:215], v[136:139], v[52:55]
  v_exp_f32 v151, v151
  v_mfma_f32_16x16x32_bf16 v[56:59], a[216:219], v[136:139], v[56:59]
  v_mfma_f32_16x16x32_bf16 v[60:63], a[220:223], v[136:139], v[60:63]
  v_mfma_f32_16x16x32_bf16 v[188:191], a[224:227], v[136:139], v[188:191]
  s_waitcnt lgkmcnt(0)
  v_mfma_f32_16x16x32_bf16 v[128:131], a[160:163], a[128:131], v[176:179]
  v_exp_f32 v152, v152
  v_add_u32 v255, s44, v253
  v_mfma_f32_16x16x32_bf16 v[128:131], a[164:167], a[132:135], v[128:131]
  v_cvt_pk_bf16_f32 v144, v144, v145
  v_cvt_pk_bf16_f32 v145, v146, v147
  v_mfma_f32_16x16x32_bf16 v[128:131], a[168:171], a[136:139], v[128:131]
  v_exp_f32 v153, v153
  v_mfma_f32_16x16x32_bf16 v[128:131], a[172:175], a[140:143], v[128:131]
  v_cvt_pk_bf16_f32 v146, v148, v149
  v_cvt_pk_bf16_f32 v147, v150, v151
  v_mfma_f32_16x16x32_bf16 v[132:135], a[176:179], a[128:131], v[176:179]
  v_exp_f32 v154, v154
  v_mfma_f32_16x16x32_bf16 v[132:135], a[180:183], a[132:135], v[132:135]
  v_add_u32 v230, s61, v211
  v_add_u32 v231, s61, v214
  v_mfma_f32_16x16x32_bf16 v[132:135], a[184:187], a[136:139], v[132:135]
  v_exp_f32 v155, v155
  v_mfma_f32_16x16x32_bf16 v[132:135], a[188:191], a[140:143], v[132:135]
  s_waitcnt vmcnt(8)
  s_barrier
  v_cvt_pk_bf16_f32 v152, v152, v153
  v_mfma_f32_16x16x32_bf16 v[136:139], a[160:163], a[144:147], v[180:183]
  v_exp_f32 v156, v156
  v_mfma_f32_16x16x32_bf16 v[136:139], a[164:167], a[148:151], v[136:139]
  ds_read_b128 a[160:163], v209 offset:16384
  v_cvt_pk_bf16_f32 v153, v154, v155
  v_mfma_f32_16x16x32_bf16 v[136:139], a[168:171], a[152:155], v[136:139]
  v_exp_f32 v157, v157
  v_exp_f32 v128, v128
  v_mfma_f32_16x16x32_bf16 v[136:139], a[172:175], a[156:159], v[136:139]
  ds_read_b128 a[164:167], v209 offset:16640
  v_cvt_pk_bf16_f32 v154, v156, v157
  v_exp_f32 v129, v129
  v_mfma_f32_16x16x32_bf16 v[140:143], a[176:179], a[144:147], v[180:183]
  v_exp_f32 v158, v158
  v_cvt_pk_bf16_f32 v128, v128, v129
  v_mfma_f32_16x16x32_bf16 v[140:143], a[180:183], a[148:151], v[140:143]
  ds_read_b128 a[168:171], v209 offset:16896
  ds_read_b128 a[172:175], v209 offset:17152
  v_mfma_f32_16x16x32_bf16 v[140:143], a[184:187], a[152:155], v[140:143]
  v_exp_f32 v159, v159
  v_mfma_f32_16x16x32_bf16 v[140:143], a[188:191], a[156:159], v[140:143]
  ds_read_b128 a[176:179], v209 offset:20480
  v_cvt_pk_bf16_f32 v155, v158, v159
  v_mfma_f32_16x16x32_bf16 v[64:67], a[192:195], v[144:147], v[64:67]
  ds_read_b128 a[180:183], v209 offset:20736
  ds_read_b128 a[184:187], v209 offset:20992
  v_mfma_f32_16x16x32_bf16 v[68:71], a[196:199], v[144:147], v[68:71]
  ds_read_b128 a[188:191], v209 offset:21248
  v_exp_f32 v130, v130
TP8:
  s_cbranch_execz L_TRET
  v_mfma_f32_16x16x32_bf16 v[72:75], a[200:203], v[144:147], v[72:75]
  v_exp_f32 v131, v131
  v_mfma_f32_16x16x32_bf16 v[76:79], a[204:207], v[144:147], v[76:79]
  v_exp_f32 v132, v132
  v_cvt_pk_bf16_f32 v129, v130, v131
  v_mfma_f32_16x16x32_bf16 v[80:83], a[208:211], v[144:147], v[80:83]
  v_exp_f32 v133, v133
  v_mfma_f32_16x16x32_bf16 v[84:87], a[212:215], v[144:147], v[84:87]
  v_exp_f32 v134, v134
  v_cvt_pk_bf16_f32 v130, v132, v133
  v_mfma_f32_16x16x32_bf16 v[88:91], a[216:219], v[144:147], v[88:91]
  v_exp_f32 v135, v135
  v_mfma_f32_16x16x32_bf16 v[92:95], a[220:223], v[144:147], v[92:95]
  v_exp_f32 v136, v136
  v_cvt_pk_bf16_f32 v131, v134, v135
  v_mfma_f32_16x16x32_bf16 v[192:195], a[224:227], v[144:147], v[192:195]
  ds_write_b128 v255, v[128:131]
  v_exp_f32 v137, v137
  v_mfma_f32_16x16x32_bf16 v[96:99], a[192:195], v[152:155], v[96:99]
  v_exp_f32 v138, v138
  v_cvt_pk_bf16_f32 v136, v136, v137
  v_mfma_f32_16x16x32_bf16 v[100:103], a[196:199], v[152:155], v[100:103]
  v_exp_f32 v139, v139
  v_mfma_f32_16x16x32_bf16 v[104:107], a[200:203], v[152:155], v[104:107]
  v_exp_f32 v140, v140
  v_cvt_pk_bf16_f32 v137, v138, v139
  v_mfma_f32_16x16x32_bf16 v[108:111], a[204:207], v[152:155], v[108:111]
  v_exp_f32 v141, v141
  v_mfma_f32_16x16x32_bf16 v[112:115], a[208:211], v[152:155], v[112:115]
  v_exp_f32 v142, v142
  v_mfma_f32_16x16x32_bf16 v[116:119], a[212:215], v[152:155], v[116:119]
  v_exp_f32 v143, v143
  v_mfma_f32_16x16x32_bf16 v[120:123], a[216:219], v[152:155], v[120:123]
  v_cvt_pk_bf16_f32 v138, v140, v141
  v_cvt_pk_bf16_f32 v139, v142, v143
  v_mfma_f32_16x16x32_bf16 v[124:127], a[220:223], v[152:155], v[124:127]
  ds_write_b128 v255, v[136:139] offset:1024
  v_mfma_f32_16x16x32_bf16 v[196:199], a[224:227], v[152:155], v[196:199]
  s_waitcnt lgkmcnt(2)
  v_mfma_f32_16x16x32_bf16 v[144:147], a[160:163], a[64:67], v[160:163]
  ds_read_b64_tr_b16 a[192:193], v218 offset:8192
  ds_read_b64_tr_b16 a[194:195], v218 offset:12288
  v_mfma_f32_16x16x32_bf16 v[144:147], a[164:167], a[68:71], v[144:147]
  s_add_u32 m0, s29, 131072
  s_nop 0
  buffer_load_dwordx4 v220, s[16:19], s72 offen nt lds
  v_mfma_f32_16x16x32_bf16 v[144:147], a[168:171], a[72:75], v[144:147]
  ds_read_b64_tr_b16 a[196:197], v219 offset:8192
  ds_read_b64_tr_b16 a[198:199], v219 offset:12288
  v_mfma_f32_16x16x32_bf16 v[144:147], a[172:175], a[76:79], v[144:147]
  buffer_load_dwordx4 v221, s[16:19], s72 offen offset:1024 nt lds
  v_mfma_f32_16x16x32_bf16 v[148:151], a[176:179], a[64:67], v[160:163]
  ds_read_b64_tr_b16 a[200:201], v218 offset:24576
  ds_read_b64_tr_b16 a[202:203], v218 offset:28672
  v_mfma_f32_16x16x32_bf16 v[148:151], a[180:183], a[68:71], v[148:151]
  s_waitcnt lgkmcnt(6)
  s_barrier
  ds_read_b64_tr_b16 a[204:205], v219 offset:24576
  v_mfma_f32_16x16x32_bf16 v[148:151], a[184:187], a[72:75], v[148:151]
  ds_read_b64_tr_b16 a[206:207], v219 offset:28672
  ds_read_b64_tr_b16 a[208:209], v230 offset:40960
  v_mfma_f32_16x16x32_bf16 v[148:151], a[188:191], a[76:79], v[148:151]
  ds_read_b64_tr_b16 a[210:211], v230 offset:45056
  ds_read_b64_tr_b16 a[212:213], v231 offset:40960
  v_mfma_f32_16x16x32_bf16 v[152:155], a[160:163], a[80:83], v[164:167]
  ds_read_b64_tr_b16 a[214:215], v231 offset:45056
  ds_read_b64_tr_b16 a[216:217], v230 offset:57344
  v_mfma_f32_16x16x32_bf16 v[152:155], a[164:167], a[84:87], v[152:155]
  ds_read_b64_tr_b16 a[218:219], v230 offset:61440
  ds_read_b64_tr_b16 a[220:221], v231 offset:57344
  v_mfma_f32_16x16x32_bf16 v[152:155], a[168:171], a[88:91], v[152:155]
  ds_read_b64_tr_b16 a[222:223], v231 offset:61440
  ds_read_b128 a[16:19], v253
  v_mfma_f32_16x16x32_bf16 v[152:155], a[172:175], a[92:95], v[152:155]
  ds_read_b128 a[24:27], v253 offset:16384
  ds_read_b128 a[32:35], v253 offset:32768
  v_mfma_f32_16x16x32_bf16 v[156:159], a[176:179], a[80:83], v[164:167]
  ds_read_b128 a[40:43], v253 offset:49152
  ds_read_b128 a[20:23], v253 offset:1024
  v_mfma_f32_16x16x32_bf16 v[156:159], a[180:183], a[84:87], v[156:159]
  ds_read_b128 a[28:31], v253 offset:17408
  ds_read_b128 a[36:39], v253 offset:33792
  v_mfma_f32_16x16x32_bf16 v[156:159], a[184:187], a[88:91], v[156:159]
  ds_read_b128 a[44:47], v253 offset:50176
  v_mfma_f32_16x16x32_bf16 v[156:159], a[188:191], a[92:95], v[156:159]
  s_waitcnt lgkmcnt(7)
  v_mfma_f32_16x16x32_bf16 a[0:3], a[192:195], a[16:19], 0
  v_exp_f32 v144, v144
  v_mfma_f32_16x16x32_bf16 a[4:7], a[196:199], a[16:19], 0
  s_waitcnt lgkmcnt(6)
  v_mfma_f32_16x16x32_bf16 a[0:3], a[200:203], a[24:27], a[0:3]
  v_exp_f32 v145, v145
  v_mfma_f32_16x16x32_bf16 a[4:7], a[204:207], a[24:27], a[4:7]
  s_waitcnt lgkmcnt(5)
  v_mfma_f32_16x16x32_bf16 a[0:3], a[208:211], a[32:35], a[0:3]
  v_exp_f32 v146, v146
  v_mfma_f32_16x16x32_bf16 a[4:7], a[212:215], a[32:35], a[4:7]
  s_waitcnt lgkmcnt(4)
  v_mfma_f32_16x16x32_bf16 a[0:3], a[216:219], a[40:43], a[0:3]
  v_exp_f32 v147, v147
  v_mfma_f32_16x16x32_bf16 a[4:7], a[220:223], a[40:43], a[4:7]
  v_mfma_f32_16x16x32_bf16 v[200:203], a[224:227], v[128:131], 0
  s_waitcnt lgkmcnt(0)
  v_exp_f32 v148, v148
  v_mfma_f32_16x16x32_bf16 a[8:11], a[192:195], a[20:23], 0
  v_mfma_f32_16x16x32_bf16 a[12:15], a[196:199], a[20:23], 0
  v_exp_f32 v149, v149
  v_mfma_f32_16x16x32_bf16 a[8:11], a[200:203], a[28:31], a[8:11]
  ds_read_b64_tr_b16 a[192:193], v212 offset:24576
  ds_read_b64_tr_b16 a[194:195], v212 offset:28672
  v_mfma_f32_16x16x32_bf16 a[12:15], a[204:207], a[28:31], a[12:15]
  v_exp_f32 v150, v150
  v_mfma_f32_16x16x32_bf16 a[8:11], a[208:211], a[36:39], a[8:11]
  ds_read_b64_tr_b16 a[196:197], v215 offset:24576
  ds_read_b64_tr_b16 a[198:199], v215 offset:28672
  v_mfma_f32_16x16x32_bf16 a[12:15], a[212:215], a[36:39], a[12:15]
  v_exp_f32 v151, v151
  v_mfma_f32_16x16x32_bf16 a[8:11], a[216:219], a[44:47], a[8:11]
  ds_read_b64_tr_b16 a[200:201], v212 offset:24832
  ds_read_b64_tr_b16 a[202:203], v212 offset:28928
  v_mfma_f32_16x16x32_bf16 a[12:15], a[220:223], a[44:47], a[12:15]
  ds_read_b64_tr_b16 a[204:205], v215 offset:24832
  ds_read_b64_tr_b16 a[206:207], v215 offset:28928
  v_mfma_f32_16x16x32_bf16 v[204:207], a[224:227], v[136:139], 0
  v_mfma_f32_16x16x32_bf16 v[128:131], a[160:163], a[96:99], v[168:171]
  v_exp_f32 v152, v152
  v_mfma_f32_16x16x32_bf16 v[128:131], a[164:167], a[100:103], v[128:131]
  ds_read_b64_tr_b16 a[208:209], v212 offset:25088
  ds_read_b64_tr_b16 a[210:211], v212 offset:29184
  v_mfma_f32_16x16x32_bf16 v[128:131], a[168:171], a[104:107], v[128:131]
  v_exp_f32 v153, v153
  v_mfma_f32_16x16x32_bf16 v[128:131], a[172:175], a[108:111], v[128:131]
  ds_read_b64_tr_b16 a[212:213], v215 offset:25088
  ds_read_b64_tr_b16 a[214:215], v215 offset:29184
  v_mfma_f32_16x16x32_bf16 v[132:135], a[176:179], a[96:99], v[168:171]
  v_exp_f32 v154, v154
  v_mfma_f32_16x16x32_bf16 v[132:135], a[180:183], a[100:103], v[132:135]
  ds_read_b64_tr_b16 a[216:217], v212 offset:25344
  ds_read_b64_tr_b16 a[218:219], v212 offset:29440
  v_mfma_f32_16x16x32_bf16 v[132:135], a[184:187], a[104:107], v[132:135]
  v_exp_f32 v155, v155
  v_mfma_f32_16x16x32_bf16 v[132:135], a[188:191], a[108:111], v[132:135]
  s_waitcnt vmcnt(6)
  s_barrier
  v_mfma_f32_16x16x32_bf16 v[136:139], a[160:163], a[112:115], v[172:175]
  v_exp_f32 v156, v156
TP9:
  s_cbranch_execz L_TRET
  v_mfma_f32_16x16x32_bf16 v[136:139], a[164:167], a[116:119], v[136:139]
  ds_read_b64_tr_b16 a[220:221], v215 offset:25344
  ds_read_b64_tr_b16 a[222:223], v215 offset:29440
  v_mfma_f32_16x16x32_bf16 v[136:139], a[168:171], a[120:123], v[136:139]
  v_exp_f32 v157, v157
  v_mfma_f32_16x16x32_bf16 v[136:139], a[172:175], a[124:127], v[136:139]
  v_cvt_pk_bf16_f32 v144, v144, v145
  v_cvt_pk_bf16_f32 v145, v146, v147
  v_mfma_f32_16x16x32_bf16 v[140:143], a[176:179], a[112:115], v[172:175]
  v_exp_f32 v158, v158
  v_mfma_f32_16x16x32_bf16 v[140:143], a[180:183], a[116:119], v[140:143]
  v_cvt_pk_bf16_f32 v146, v148, v149
  v_cvt_pk_bf16_f32 v147, v150, v151
  v_mfma_f32_16x16x32_bf16 v[140:143], a[184:187], a[120:123], v[140:143]
  v_exp_f32 v159, v159
  v_mfma_f32_16x16x32_bf16 v[140:143], a[188:191], a[124:127], v[140:143]
  s_waitcnt lgkmcnt(2)
  v_cvt_pk_bf16_f32 v152, v152, v153
  v_cvt_pk_bf16_f32 v153, v154, v155
  v_mfma_f32_16x16x32_bf16 v[0:3], a[192:195], v[144:147], v[0:3]
  v_exp_f32 v128, v128
  v_mfma_f32_16x16x32_bf16 v[4:7], a[196:199], v[144:147], v[4:7]
  v_cvt_pk_bf16_f32 v154, v156, v157
  v_cvt_pk_bf16_f32 v155, v158, v159
  v_mfma_f32_16x16x32_bf16 v[8:11], a[200:203], v[144:147], v[8:11]
  v_exp_f32 v129, v129
  v_mfma_f32_16x16x32_bf16 v[12:15], a[204:207], v[144:147], v[12:15]
  ds_read_b128 a[160:163], v209 offset:32768
  ds_read_b128 a[164:167], v209 offset:33024
  v_mfma_f32_16x16x32_bf16 v[16:19], a[208:211], v[144:147], v[16:19]
  v_exp_f32 v130, v130
  v_mfma_f32_16x16x32_bf16 v[20:23], a[212:215], v[144:147], v[20:23]
  ds_read_b128 a[168:171], v209 offset:33280
  ds_read_b128 a[172:175], v209 offset:33536
  v_mfma_f32_16x16x32_bf16 v[24:27], a[216:219], v[144:147], v[24:27]
  s_waitcnt lgkmcnt(4)
  v_exp_f32 v131, v131
  v_mfma_f32_16x16x32_bf16 v[28:31], a[220:223], v[144:147], v[28:31]
  ds_read_b128 a[176:179], v209 offset:36864
  ds_read_b128 a[180:183], v209 offset:37120
  v_mfma_f32_16x16x32_bf16 v[184:187], a[224:227], v[144:147], v[184:187]
  v_exp_f32 v132, v132
  v_mfma_f32_16x16x32_bf16 v[32:35], a[192:195], v[152:155], v[32:35]
  ds_read_b128 a[184:187], v209 offset:37376
  ds_read_b128 a[188:191], v209 offset:37632
  v_mfma_f32_16x16x32_bf16 v[36:39], a[196:199], v[152:155], v[36:39]
  v_exp_f32 v133, v133
  v_mfma_f32_16x16x32_bf16 v[40:43], a[200:203], v[152:155], v[40:43]
  s_add_u32 m0, s29, 139264
  v_and_b32 v241, 15, v224
  v_mfma_f32_16x16x32_bf16 v[44:47], a[204:207], v[152:155], v[44:47]
  v_exp_f32 v134, v134
  v_mfma_f32_16x16x32_bf16 v[48:51], a[208:211], v[152:155], v[48:51]
  buffer_load_dwordx4 v222, s[20:23], s72 offen nt lds
  v_mfma_f32_16x16x32_bf16 v[52:55], a[212:215], v[152:155], v[52:55]
  v_exp_f32 v135, v135
  v_mfma_f32_16x16x32_bf16 v[56:59], a[216:219], v[152:155], v[56:59]
  buffer_load_dwordx4 v223, s[20:23], s72 offen offset:1024 nt lds
  v_mfma_f32_16x16x32_bf16 v[60:63], a[220:223], v[152:155], v[60:63]
  s_lshl_b32 s48, s28, 13
  s_add_u32 s48, s48, 98304
  v_lshrrev_b32 v242, 5, v224
  v_mfma_f32_16x16x32_bf16 v[188:191], a[224:227], v[152:155], v[188:191]
  s_waitcnt lgkmcnt(2)
  v_lshlrev_b32 v226, 8, v241
  v_and_b32 v241, 7, v224
  v_mfma_f32_16x16x32_bf16 v[144:147], a[160:163], a[64:67], v[160:163]
  v_exp_f32 v136, v136
  v_mfma_f32_16x16x32_bf16 v[144:147], a[164:167], a[68:71], v[144:147]
  v_cvt_pk_bf16_f32 v128, v128, v129
  v_cvt_pk_bf16_f32 v129, v130, v131
  v_mfma_f32_16x16x32_bf16 v[144:147], a[168:171], a[72:75], v[144:147]
  v_exp_f32 v137, v137
  v_mfma_f32_16x16x32_bf16 v[144:147], a[172:175], a[76:79], v[144:147]
  v_cvt_pk_bf16_f32 v130, v132, v133
  v_cvt_pk_bf16_f32 v131, v134, v135
  v_mfma_f32_16x16x32_bf16 v[148:151], a[176:179], a[64:67], v[160:163]
  v_exp_f32 v138, v138
  v_mfma_f32_16x16x32_bf16 v[148:151], a[180:183], a[68:71], v[148:151]
  s_waitcnt lgkmcnt(0)
  s_add_u32 m0, s29, 147456
  v_cvt_pk_bf16_f32 v136, v136, v137
  v_mfma_f32_16x16x32_bf16 v[148:151], a[184:187], a[72:75], v[148:151]
  v_exp_f32 v139, v139
  v_mfma_f32_16x16x32_bf16 v[148:151], a[188:191], a[76:79], v[148:151]
  v_cvt_pk_bf16_f32 v137, v138, v139
  v_xor_b32 v242, v242, v241
  v_mfma_f32_16x16x32_bf16 v[152:155], a[160:163], a[80:83], v[164:167]
  v_exp_f32 v140, v140
  v_mfma_f32_16x16x32_bf16 v[152:155], a[164:167], a[84:87], v[152:155]
  buffer_load_dwordx4 v220, s[16:19], s73 offen nt lds
  v_mfma_f32_16x16x32_bf16 v[152:155], a[168:171], a[88:91], v[152:155]
  v_exp_f32 v141, v141
  v_mfma_f32_16x16x32_bf16 v[152:155], a[172:175], a[92:95], v[152:155]
  v_cvt_pk_bf16_f32 v138, v140, v141
  v_lshl_add_u32 v226, v242, 4, v226
  v_mfma_f32_16x16x32_bf16 v[156:159], a[176:179], a[80:83], v[164:167]
  v_exp_f32 v142, v142
  v_mfma_f32_16x16x32_bf16 v[156:159], a[180:183], a[84:87], v[156:159]
  buffer_load_dwordx4 v221, s[16:19], s73 offen offset:1024 nt lds
  v_mfma_f32_16x16x32_bf16 v[156:159], a[184:187], a[88:91], v[156:159]
  v_exp_f32 v143, v143
  v_mfma_f32_16x16x32_bf16 v[156:159], a[188:191], a[92:95], v[156:159]
  s_add_u32 m0, s29, 155648
  v_cvt_pk_bf16_f32 v139, v142, v143
  v_mfma_f32_16x16x32_bf16 v[64:67], a[192:195], v[128:131], v[64:67]
  v_exp_f32 v144, v144
  v_mfma_f32_16x16x32_bf16 v[68:71], a[196:199], v[128:131], v[68:71]
  buffer_load_dwordx4 v222, s[20:23], s73 offen nt lds
  v_mfma_f32_16x16x32_bf16 v[72:75], a[200:203], v[128:131], v[72:75]
  v_exp_f32 v145, v145
  v_mfma_f32_16x16x32_bf16 v[76:79], a[204:207], v[128:131], v[76:79]
  buffer_load_dwordx4 v223, s[20:23], s73 offen offset:1024 nt lds
  v_mfma_f32_16x16x32_bf16 v[80:83], a[208:211], v[128:131], v[80:83]
  v_exp_f32 v146, v146
  v_mfma_f32_16x16x32_bf16 v[84:87], a[212:215], v[128:131], v[84:87]
  v_bfe_u32 v242, v224, 4, 1
  v_lshl_add_u32 v226, v242, 3, v226
  v_mfma_f32_16x16x32_bf16 v[88:91], a[216:219], v[128:131], v[88:91]
  v_exp_f32 v147, v147
  v_mfma_f32_16x16x32_bf16 v[92:95], a[220:223], v[128:131], v[92:95]
  v_add_u32 v226, s48, v226
  v_xor_b32 v227, 32, v226
  v_mfma_f32_16x16x32_bf16 v[192:195], a[224:227], v[128:131], v[192:195]
  v_exp_f32 v148, v148
  v_mfma_f32_16x16x32_bf16 v[96:99], a[192:195], v[136:139], v[96:99]
  v_xor_b32 v228, 64, v226
  v_xor_b32 v229, 96, v226
  v_mfma_f32_16x16x32_bf16 v[100:103], a[196:199], v[136:139], v[100:103]
  v_exp_f32 v149, v149
  v_mfma_f32_16x16x32_bf16 v[104:107], a[200:203], v[136:139], v[104:107]
  ds_read_b64_tr_b16 a[192:193], v212 offset:40960
  ds_read_b64_tr_b16 a[194:195], v212 offset:45056
  v_mfma_f32_16x16x32_bf16 v[108:111], a[204:207], v[136:139], v[108:111]
  v_exp_f32 v150, v150
  v_mfma_f32_16x16x32_bf16 v[112:115], a[208:211], v[136:139], v[112:115]
  ds_read_b64_tr_b16 a[196:197], v215 offset:40960
  ds_read_b64_tr_b16 a[198:199], v215 offset:45056
  v_mfma_f32_16x16x32_bf16 v[116:119], a[212:215], v[136:139], v[116:119]
  v_exp_f32 v151, v151
  v_mfma_f32_16x16x32_bf16 v[120:123], a[216:219], v[136:139], v[120:123]
  ds_read_b64_tr_b16 a[200:201], v212 offset:41216
  ds_read_b64_tr_b16 a[202:203], v212 offset:45312
  v_mfma_f32_16x16x32_bf16 v[124:127], a[220:223], v[136:139], v[124:127]
  ds_read_b64_tr_b16 a[204:205], v215 offset:41216
  ds_read_b64_tr_b16 a[206:207], v215 offset:45312
  v_mfma_f32_16x16x32_bf16 v[196:199], a[224:227], v[136:139], v[196:199]
  v_lshrrev_b32 v242, 4, v224
  v_xor_b32 v241, v241, v242
TP10:
  s_cbranch_execz L_TRET
  v_mfma_f32_16x16x32_bf16 v[128:131], a[160:163], a[96:99], v[168:171]
  v_exp_f32 v152, v152
  v_mfma_f32_16x16x32_bf16 v[128:131], a[164:167], a[100:103], v[128:131]
  ds_read_b64_tr_b16 a[208:209], v212 offset:41472
  ds_read_b64_tr_b16 a[210:211], v212 offset:45568
  v_mfma_f32_16x16x32_bf16 v[128:131], a[168:171], a[104:107], v[128:131]
  v_exp_f32 v153, v153
  v_mfma_f32_16x16x32_bf16 v[128:131], a[172:175], a[108:111], v[128:131]
  ds_read_b64_tr_b16 a[212:213], v215 offset:41472
  ds_read_b64_tr_b16 a[214:215], v215 offset:45568
  v_mfma_f32_16x16x32_bf16 v[132:135], a[176:179], a[96:99], v[168:171]
  v_exp_f32 v154, v154
  v_mfma_f32_16x16x32_bf16 v[132:135], a[180:183], a[100:103], v[132:135]
  ds_read_b64_tr_b16 a[216:217], v212 offset:41728
  ds_read_b64_tr_b16 a[218:219], v212 offset:45824
  v_mfma_f32_16x16x32_bf16 v[132:135], a[184:187], a[104:107], v[132:135]
  v_exp_f32 v155, v155
  v_mfma_f32_16x16x32_bf16 v[132:135], a[188:191], a[108:111], v[132:135]
  s_waitcnt vmcnt(8)
  s_barrier
  v_mfma_f32_16x16x32_bf16 v[136:139], a[160:163], a[112:115], v[172:175]
  v_exp_f32 v156, v156
  v_mfma_f32_16x16x32_bf16 v[136:139], a[164:167], a[116:119], v[136:139]
  ds_read_b64_tr_b16 a[220:221], v215 offset:41728
  ds_read_b64_tr_b16 a[222:223], v215 offset:45824
  v_mfma_f32_16x16x32_bf16 v[136:139], a[168:171], a[120:123], v[136:139]
  v_exp_f32 v157, v157
  v_mfma_f32_16x16x32_bf16 v[136:139], a[172:175], a[124:127], v[136:139]
  v_cvt_pk_bf16_f32 v144, v144, v145
  v_cvt_pk_bf16_f32 v145, v146, v147
  v_mfma_f32_16x16x32_bf16 v[140:143], a[176:179], a[112:115], v[172:175]
  v_exp_f32 v158, v158
  v_mfma_f32_16x16x32_bf16 v[140:143], a[180:183], a[116:119], v[140:143]
  v_cvt_pk_bf16_f32 v146, v148, v149
  v_cvt_pk_bf16_f32 v147, v150, v151
  v_mfma_f32_16x16x32_bf16 v[140:143], a[184:187], a[120:123], v[140:143]
  v_exp_f32 v159, v159
  v_mfma_f32_16x16x32_bf16 v[140:143], a[188:191], a[124:127], v[140:143]
  s_waitcnt lgkmcnt(2)
  v_cvt_pk_bf16_f32 v152, v152, v153
  v_cvt_pk_bf16_f32 v153, v154, v155
  v_mfma_f32_16x16x32_bf16 v[0:3], a[192:195], v[144:147], v[0:3]
  v_exp_f32 v128, v128
  v_mfma_f32_16x16x32_bf16 v[4:7], a[196:199], v[144:147], v[4:7]
  v_cvt_pk_bf16_f32 v154, v156, v157
  v_cvt_pk_bf16_f32 v155, v158, v159
  v_mfma_f32_16x16x32_bf16 v[8:11], a[200:203], v[144:147], v[8:11]
  v_exp_f32 v129, v129
  v_mfma_f32_16x16x32_bf16 v[12:15], a[204:207], v[144:147], v[12:15]
  ds_read_b128 a[160:163], v209 offset:49152
  ds_read_b128 a[164:167], v209 offset:49408
  v_mfma_f32_16x16x32_bf16 v[16:19], a[208:211], v[144:147], v[16:19]
  v_exp_f32 v130, v130
  v_mfma_f32_16x16x32_bf16 v[20:23], a[212:215], v[144:147], v[20:23]
  ds_read_b128 a[168:171], v209 offset:49664
  ds_read_b128 a[172:175], v209 offset:49920
  v_mfma_f32_16x16x32_bf16 v[24:27], a[216:219], v[144:147], v[24:27]
  s_waitcnt lgkmcnt(4)
  v_exp_f32 v131, v131
  v_mfma_f32_16x16x32_bf16 v[28:31], a[220:223], v[144:147], v[28:31]
  ds_read_b128 a[176:179], v209 offset:53248
  ds_read_b128 a[180:183], v209 offset:53504
  v_mfma_f32_16x16x32_bf16 v[184:187], a[224:227], v[144:147], v[184:187]
  v_exp_f32 v132, v132
  v_mfma_f32_16x16x32_bf16 v[32:35], a[192:195], v[152:155], v[32:35]
  ds_read_b128 a[184:187], v209 offset:53760
  ds_read_b128 a[188:191], v209 offset:54016
  v_mfma_f32_16x16x32_bf16 v[36:39], a[196:199], v[152:155], v[36:39]
  v_exp_f32 v133, v133
  v_mfma_f32_16x16x32_bf16 v[40:43], a[200:203], v[152:155], v[40:43]
  v_lshlrev_b32 v233, 8, v242
  v_lshl_add_u32 v233, v241, 4, v233
  v_mfma_f32_16x16x32_bf16 v[44:47], a[204:207], v[152:155], v[44:47]
  v_exp_f32 v134, v134
  v_mfma_f32_16x16x32_bf16 v[48:51], a[208:211], v[152:155], v[48:51]
  v_bfe_u32 v241, v224, 3, 1
  v_lshl_add_u32 v233, v241, 7, v233
  v_mfma_f32_16x16x32_bf16 v[52:55], a[212:215], v[152:155], v[52:55]
  v_exp_f32 v135, v135
  v_mfma_f32_16x16x32_bf16 v[56:59], a[216:219], v[152:155], v[56:59]
  v_add_u32 v233, s48, v233
  v_xor_b32 v234, 64, v233
  v_mfma_f32_16x16x32_bf16 v[60:63], a[220:223], v[152:155], v[60:63]
  v_lshlrev_b32 v235, 4, v224
  v_mov_b32 v236, 0x7f800000
  v_mfma_f32_16x16x32_bf16 v[188:191], a[224:227], v[152:155], v[188:191]
  s_waitcnt lgkmcnt(2)
  s_lshl_b32 s39, s28, 2
  v_and_b32 v241, 15, v224
  v_lshlrev_b32 v246, 4, v241
  v_mfma_f32_16x16x32_bf16 v[144:147], a[160:163], a[64:67], v[160:163]
  v_exp_f32 v136, v136
  v_mfma_f32_16x16x32_bf16 v[144:147], a[164:167], a[68:71], v[144:147]
  v_cvt_pk_bf16_f32 v128, v128, v129
  v_cvt_pk_bf16_f32 v129, v130, v131
  v_mfma_f32_16x16x32_bf16 v[144:147], a[168:171], a[72:75], v[144:147]
  v_exp_f32 v137, v137
  v_mfma_f32_16x16x32_bf16 v[144:147], a[172:175], a[76:79], v[144:147]
  v_cvt_pk_bf16_f32 v130, v132, v133
  v_cvt_pk_bf16_f32 v131, v134, v135
  v_mfma_f32_16x16x32_bf16 v[148:151], a[176:179], a[64:67], v[160:163]
  v_exp_f32 v138, v138
  v_mfma_f32_16x16x32_bf16 v[148:151], a[180:183], a[68:71], v[148:151]
  s_waitcnt lgkmcnt(0)
  s_mov_b32 m0, s29
  v_cvt_pk_bf16_f32 v136, v136, v137
  v_mfma_f32_16x16x32_bf16 v[148:151], a[184:187], a[72:75], v[148:151]
  v_exp_f32 v139, v139
  v_mfma_f32_16x16x32_bf16 v[148:151], a[188:191], a[76:79], v[148:151]
  v_cvt_pk_bf16_f32 v137, v138, v139
  v_add_u32 v245, s39, v246
  v_mfma_f32_16x16x32_bf16 v[152:155], a[160:163], a[80:83], v[164:167]
  v_exp_f32 v140, v140
  v_mfma_f32_16x16x32_bf16 v[152:155], a[164:167], a[84:87], v[152:155]
  buffer_load_dwordx4 v220, s[16:19], s74 offen nt lds
  v_mfma_f32_16x16x32_bf16 v[152:155], a[168:171], a[88:91], v[152:155]
  v_exp_f32 v141, v141
  v_mfma_f32_16x16x32_bf16 v[152:155], a[172:175], a[92:95], v[152:155]
  v_cvt_pk_bf16_f32 v138, v140, v141
  v_add_u32 v247, s39, v235
  v_mfma_f32_16x16x32_bf16 v[156:159], a[176:179], a[80:83], v[164:167]
  v_exp_f32 v142, v142
  v_mfma_f32_16x16x32_bf16 v[156:159], a[180:183], a[84:87], v[156:159]
  buffer_load_dwordx4 v221, s[16:19], s74 offen offset:1024 nt lds
  v_mfma_f32_16x16x32_bf16 v[156:159], a[184:187], a[88:91], v[156:159]
  v_exp_f32 v143, v143
  v_mfma_f32_16x16x32_bf16 v[156:159], a[188:191], a[92:95], v[156:159]
  s_add_u32 m0, s29, 8192
  v_cvt_pk_bf16_f32 v139, v142, v143
  v_mfma_f32_16x16x32_bf16 v[64:67], a[192:195], v[128:131], v[64:67]
  v_exp_f32 v144, v144
  v_mfma_f32_16x16x32_bf16 v[68:71], a[196:199], v[128:131], v[68:71]
  buffer_load_dwordx4 v222, s[20:23], s74 offen nt lds
  v_mfma_f32_16x16x32_bf16 v[72:75], a[200:203], v[128:131], v[72:75]
  v_exp_f32 v145, v145
  v_mfma_f32_16x16x32_bf16 v[76:79], a[204:207], v[128:131], v[76:79]
  buffer_load_dwordx4 v223, s[20:23], s74 offen offset:1024 nt lds
  v_mfma_f32_16x16x32_bf16 v[80:83], a[208:211], v[128:131], v[80:83]
  v_exp_f32 v146, v146
  v_mfma_f32_16x16x32_bf16 v[84:87], a[212:215], v[128:131], v[84:87]
  v_lshlrev_b32 v243, 8, v241
  v_bfe_u32 v241, v224, 4, 1
  v_mfma_f32_16x16x32_bf16 v[88:91], a[216:219], v[128:131], v[88:91]
  v_exp_f32 v147, v147
  v_mfma_f32_16x16x32_bf16 v[92:95], a[220:223], v[128:131], v[92:95]
  v_lshl_add_u32 v243, v241, 5, v243
  v_lshrrev_b32 v241, 5, v224
  v_mfma_f32_16x16x32_bf16 v[192:195], a[224:227], v[128:131], v[192:195]
  v_exp_f32 v148, v148
  v_mfma_f32_16x16x32_bf16 v[96:99], a[192:195], v[136:139], v[96:99]
  s_lshl_b32 s49, s28, 6
  s_add_u32 s49, s49, 65536
  v_lshl_add_u32 v243, v241, 4, v243
TP11:
  s_cbranch_execz L_TRET
  v_mfma_f32_16x16x32_bf16 v[100:103], a[196:199], v[136:139], v[100:103]
  s_add_u32 s64, s43, 4096
  v_exp_f32 v149, v149
  v_mfma_f32_16x16x32_bf16 v[104:107], a[200:203], v[136:139], v[104:107]
  ds_read_b64_tr_b16 a[192:193], v212 offset:57344
  ds_read_b64_tr_b16 a[194:195], v212 offset:61440
  s_add_u32 s65, s43, 8192
  v_mfma_f32_16x16x32_bf16 v[108:111], a[204:207], v[136:139], v[108:111]
  s_add_u32 s66, s43, 12288
  v_exp_f32 v150, v150
  v_mfma_f32_16x16x32_bf16 v[112:115], a[208:211], v[136:139], v[112:115]
  ds_read_b64_tr_b16 a[196:197], v215 offset:57344
  ds_read_b64_tr_b16 a[198:199], v215 offset:61440
  v_mfma_f32_16x16x32_bf16 v[116:119], a[212:215], v[136:139], v[116:119]
  v_exp_f32 v151, v151
  v_mfma_f32_16x16x32_bf16 v[120:123], a[216:219], v[136:139], v[120:123]
  ds_read_b64_tr_b16 a[200:201], v212 offset:57600
  ds_read_b64_tr_b16 a[202:203], v212 offset:61696
  v_mfma_f32_16x16x32_bf16 v[124:127], a[220:223], v[136:139], v[124:127]
  ds_read_b64_tr_b16 a[204:205], v215 offset:57600
  ds_read_b64_tr_b16 a[206:207], v215 offset:61696
  v_mfma_f32_16x16x32_bf16 v[196:199], a[224:227], v[136:139], v[196:199]
  v_mfma_f32_16x16x32_bf16 v[128:131], a[160:163], a[96:99], v[168:171]
  v_exp_f32 v152, v152
  v_mfma_f32_16x16x32_bf16 v[128:131], a[164:167], a[100:103], v[128:131]
  ds_read_b64_tr_b16 a[208:209], v212 offset:57856
  v_add_u32 v217, s45, v208
  v_mfma_f32_16x16x32_bf16 v[128:131], a[168:171], a[104:107], v[128:131]
  v_exp_f32 v153, v153
  v_mfma_f32_16x16x32_bf16 v[128:131], a[172:175], a[108:111], v[128:131]
  ds_read_b64_tr_b16 a[210:211], v212 offset:61952
  ds_read_b64_tr_b16 a[212:213], v215 offset:57856
  v_mfma_f32_16x16x32_bf16 v[132:135], a[176:179], a[96:99], v[168:171]
  v_exp_f32 v154, v154
  v_mfma_f32_16x16x32_bf16 v[132:135], a[180:183], a[100:103], v[132:135]
  ds_read_b64_tr_b16 a[214:215], v215 offset:61952
  ds_read_b64_tr_b16 a[216:217], v212 offset:58112
  v_mfma_f32_16x16x32_bf16 v[132:135], a[184:187], a[104:107], v[132:135]
  v_exp_f32 v155, v155
  v_mfma_f32_16x16x32_bf16 v[132:135], a[188:191], a[108:111], v[132:135]
  ds_read_b64_tr_b16 a[218:219], v212 offset:62208
  ds_read_b64_tr_b16 a[220:221], v215 offset:58112
  v_mfma_f32_16x16x32_bf16 v[136:139], a[160:163], a[112:115], v[172:175]
  v_exp_f32 v156, v156
  v_mfma_f32_16x16x32_bf16 v[136:139], a[164:167], a[116:119], v[136:139]
  ds_read_b64_tr_b16 a[222:223], v215 offset:62208
  v_cvt_pk_bf16_f32 v144, v144, v145
  v_mfma_f32_16x16x32_bf16 v[136:139], a[168:171], a[120:123], v[136:139]
  v_exp_f32 v157, v157
  v_mfma_f32_16x16x32_bf16 v[136:139], a[172:175], a[124:127], v[136:139]
  v_cvt_pk_bf16_f32 v145, v146, v147
  v_cvt_pk_bf16_f32 v146, v148, v149
  v_mfma_f32_16x16x32_bf16 v[140:143], a[176:179], a[112:115], v[172:175]
  v_exp_f32 v158, v158
  v_mfma_f32_16x16x32_bf16 v[140:143], a[180:183], a[116:119], v[140:143]
  v_cvt_pk_bf16_f32 v147, v150, v151
  v_cvt_pk_bf16_f32 v152, v152, v153
  v_mfma_f32_16x16x32_bf16 v[140:143], a[184:187], a[120:123], v[140:143]
  v_exp_f32 v159, v159
  v_mfma_f32_16x16x32_bf16 v[140:143], a[188:191], a[124:127], v[140:143]
  s_waitcnt lgkmcnt(3)
  v_cvt_pk_bf16_f32 v153, v154, v155
  v_cvt_pk_bf16_f32 v154, v156, v157
  v_mfma_f32_16x16x32_bf16 v[0:3], a[192:195], v[144:147], v[0:3]
  v_exp_f32 v128, v128
  v_mfma_f32_16x16x32_bf16 v[4:7], a[196:199], v[144:147], v[4:7]
  ds_read_b128 a[160:163], v217
  v_cvt_pk_bf16_f32 v155, v158, v159
  v_mfma_f32_16x16x32_bf16 v[8:11], a[200:203], v[144:147], v[8:11]
  v_exp_f32 v129, v129
  v_mfma_f32_16x16x32_bf16 v[12:15], a[204:207], v[144:147], v[12:15]
  ds_read_b128 a[164:167], v217 offset:256
  ds_read_b128 a[168:171], v217 offset:512
  v_mfma_f32_16x16x32_bf16 v[16:19], a[208:211], v[144:147], v[16:19]
  v_exp_f32 v130, v130
  v_mfma_f32_16x16x32_bf16 v[20:23], a[212:215], v[144:147], v[20:23]
  s_waitcnt lgkmcnt(3)
  ds_read_b128 a[172:175], v217 offset:768
  ds_read_b128 a[176:179], v217 offset:4096
  v_mfma_f32_16x16x32_bf16 v[24:27], a[216:219], v[144:147], v[24:27]
  v_exp_f32 v131, v131
  v_mfma_f32_16x16x32_bf16 v[28:31], a[220:223], v[144:147], v[28:31]
  ds_read_b128 a[180:183], v217 offset:4352
  ds_read_b128 a[184:187], v217 offset:4608
  v_mfma_f32_16x16x32_bf16 v[184:187], a[224:227], v[144:147], v[184:187]
  v_exp_f32 v132, v132
  v_mfma_f32_16x16x32_bf16 v[32:35], a[192:195], v[152:155], v[32:35]
  ds_read_b128 a[188:191], v217 offset:4864
  v_mfma_f32_16x16x32_bf16 v[36:39], a[196:199], v[152:155], v[36:39]
  v_exp_f32 v133, v133
  v_mfma_f32_16x16x32_bf16 v[40:43], a[200:203], v[152:155], v[40:43]
  v_mfma_f32_16x16x32_bf16 v[44:47], a[204:207], v[152:155], v[44:47]
  v_exp_f32 v134, v134
  v_mfma_f32_16x16x32_bf16 v[48:51], a[208:211], v[152:155], v[48:51]
  v_mfma_f32_16x16x32_bf16 v[52:55], a[212:215], v[152:155], v[52:55]
  v_exp_f32 v135, v135
  v_mfma_f32_16x16x32_bf16 v[56:59], a[216:219], v[152:155], v[56:59]
  v_mfma_f32_16x16x32_bf16 v[60:63], a[220:223], v[152:155], v[60:63]
  v_mfma_f32_16x16x32_bf16 v[188:191], a[224:227], v[152:155], v[188:191]
  s_waitcnt lgkmcnt(1)
  v_mfma_f32_16x16x32_bf16 v[144:147], a[160:163], a[128:131], v[176:179]
  v_exp_f32 v136, v136
  v_add_u32 v255, s45, v253
  v_mfma_f32_16x16x32_bf16 v[144:147], a[164:167], a[132:135], v[144:147]
  s_add_u32 m0, s29, 16384
  s_nop 0
  buffer_load_dwordx4 v220, s[16:19], s75 offen nt lds
  v_mfma_f32_16x16x32_bf16 v[144:147], a[168:171], a[136:139], v[144:147]
  v_exp_f32 v137, v137
  v_mfma_f32_16x16x32_bf16 v[144:147], a[172:175], a[140:143], v[144:147]
  buffer_load_dwordx4 v221, s[16:19], s75 offen offset:1024 nt lds
  v_mfma_f32_16x16x32_bf16 v[148:151], a[176:179], a[128:131], v[176:179]
  v_exp_f32 v138, v138
  v_mfma_f32_16x16x32_bf16 v[148:151], a[180:183], a[132:135], v[148:151]
  v_cvt_pk_bf16_f32 v128, v128, v129
  v_cvt_pk_bf16_f32 v129, v130, v131
  v_mfma_f32_16x16x32_bf16 v[148:151], a[184:187], a[136:139], v[148:151]
  s_waitcnt lgkmcnt(0)
  v_exp_f32 v139, v139
  v_mfma_f32_16x16x32_bf16 v[148:151], a[188:191], a[140:143], v[148:151]
  s_waitcnt vmcnt(10)
  s_barrier
  v_cvt_pk_bf16_f32 v130, v132, v133
  v_mfma_f32_16x16x32_bf16 v[152:155], a[160:163], a[144:147], v[180:183]
  v_exp_f32 v140, v140
  v_mfma_f32_16x16x32_bf16 v[152:155], a[164:167], a[148:151], v[152:155]
  v_cvt_pk_bf16_f32 v131, v134, v135
  v_add_u32 v218, s61, v212
  v_mfma_f32_16x16x32_bf16 v[152:155], a[168:171], a[152:155], v[152:155]
  v_exp_f32 v141, v141
  v_exp_f32 v144, v144
  v_mfma_f32_16x16x32_bf16 v[152:155], a[172:175], a[156:159], v[152:155]
  v_add_u32 v219, s61, v215
  v_add_u32 v230, s61, v212
  v_exp_f32 v145, v145
  v_mfma_f32_16x16x32_bf16 v[156:159], a[176:179], a[144:147], v[180:183]
  v_exp_f32 v142, v142
  v_exp_f32 v146, v146
  v_cvt_pk_bf16_f32 v144, v144, v145
  v_mfma_f32_16x16x32_bf16 v[156:159], a[180:183], a[148:151], v[156:159]
  v_add_u32 v231, s61, v215
  v_cvt_pk_bf16_f32 v136, v136, v137
  v_exp_f32 v147, v147
  v_mfma_f32_16x16x32_bf16 v[156:159], a[184:187], a[152:155], v[156:159]
  v_exp_f32 v143, v143
  v_exp_f32 v148, v148
  v_cvt_pk_bf16_f32 v145, v146, v147
  v_mfma_f32_16x16x32_bf16 v[156:159], a[188:191], a[156:159], v[156:159]
  v_cvt_pk_bf16_f32 v137, v138, v139
  v_cvt_pk_bf16_f32 v138, v140, v141
TP12:
  s_cbranch_execz L_TRET
  v_mfma_f32_16x16x32_bf16 v[64:67], a[192:195], v[128:131], v[64:67]
  ds_read_b128 a[160:163], v210
  v_cvt_pk_bf16_f32 v139, v142, v143
  v_mfma_f32_16x16x32_bf16 v[68:71], a[196:199], v[128:131], v[68:71]
  ds_read_b128 a[164:167], v210 offset:256
  ds_read_b128 a[168:171], v210 offset:512
  v_mfma_f32_16x16x32_bf16 v[72:75], a[200:203], v[128:131], v[72:75]
  ds_read_b128 a[172:175], v210 offset:768
  ds_read_b128 a[176:179], v210 offset:4096
  v_mfma_f32_16x16x32_bf16 v[76:79], a[204:207], v[128:131], v[76:79]
  ds_read_b128 a[180:183], v210 offset:4352
  ds_read_b128 a[184:187], v210 offset:4608
  v_mfma_f32_16x16x32_bf16 v[80:83], a[208:211], v[128:131], v[80:83]
  ds_read_b128 a[188:191], v210 offset:4864
  v_exp_f32 v149, v149
  v_mfma_f32_16x16x32_bf16 v[84:87], a[212:215], v[128:131], v[84:87]
  v_exp_f32 v150, v150
  v_cvt_pk_bf16_f32 v146, v148, v149
  v_mfma_f32_16x16x32_bf16 v[88:91], a[216:219], v[128:131], v[88:91]
  v_exp_f32 v151, v151
  v_mfma_f32_16x16x32_bf16 v[92:95], a[220:223], v[128:131], v[92:95]
  v_exp_f32 v152, v152
  v_cvt_pk_bf16_f32 v147, v150, v151
  v_mfma_f32_16x16x32_bf16 v[192:195], a[224:227], v[128:131], v[192:195]
  ds_write_b128 v255, v[144:147]
  v_exp_f32 v153, v153
  v_mfma_f32_16x16x32_bf16 v[96:99], a[192:195], v[136:139], v[96:99]
  v_exp_f32 v154, v154
  v_cvt_pk_bf16_f32 v152, v152, v153
  v_mfma_f32_16x16x32_bf16 v[100:103], a[196:199], v[136:139], v[100:103]
  v_exp_f32 v155, v155
  v_mfma_f32_16x16x32_bf16 v[104:107], a[200:203], v[136:139], v[104:107]
  v_exp_f32 v156, v156
  v_cvt_pk_bf16_f32 v153, v154, v155
  v_mfma_f32_16x16x32_bf16 v[108:111], a[204:207], v[136:139], v[108:111]
  v_exp_f32 v157, v157
  v_mfma_f32_16x16x32_bf16 v[112:115], a[208:211], v[136:139], v[112:115]
  v_exp_f32 v158, v158
  v_mfma_f32_16x16x32_bf16 v[116:119], a[212:215], v[136:139], v[116:119]
  v_exp_f32 v159, v159
  v_mfma_f32_16x16x32_bf16 v[120:123], a[216:219], v[136:139], v[120:123]
  v_cvt_pk_bf16_f32 v154, v156, v157
  v_cvt_pk_bf16_f32 v155, v158, v159
  v_mfma_f32_16x16x32_bf16 v[124:127], a[220:223], v[136:139], v[124:127]
  ds_write_b128 v255, v[152:155] offset:1024
  v_mfma_f32_16x16x32_bf16 v[196:199], a[224:227], v[136:139], v[196:199]
  s_waitcnt lgkmcnt(2)
  v_mfma_f32_16x16x32_bf16 v[128:131], a[160:163], a[64:67], v[160:163]
  ds_read_b64_tr_b16 a[192:193], v218 offset:8192
  ds_read_b64_tr_b16 a[194:195], v218 offset:12288
  v_mfma_f32_16x16x32_bf16 v[128:131], a[164:167], a[68:71], v[128:131]
  s_add_u32 m0, s29, 24576
  s_nop 0
  buffer_load_dwordx4 v222, s[20:23], s75 offen nt lds
  v_add_u32 v254, 65536, v253
  v_mfma_f32_16x16x32_bf16 v[128:131], a[168:171], a[72:75], v[128:131]
  ds_read_b64_tr_b16 a[196:197], v219 offset:8192
  ds_read_b64_tr_b16 a[198:199], v219 offset:12288
  v_mfma_f32_16x16x32_bf16 v[128:131], a[172:175], a[76:79], v[128:131]
  buffer_load_dwordx4 v223, s[20:23], s75 offen offset:1024 nt lds
  v_mfma_f32_16x16x32_bf16 v[132:135], a[176:179], a[64:67], v[160:163]
  ds_read_b64_tr_b16 a[200:201], v218 offset:24576
  ds_read_b64_tr_b16 a[202:203], v218 offset:28672
  v_mfma_f32_16x16x32_bf16 v[132:135], a[180:183], a[68:71], v[132:135]
  s_waitcnt lgkmcnt(6)
  s_barrier
  ds_read_b64_tr_b16 a[204:205], v219 offset:24576
  v_mfma_f32_16x16x32_bf16 v[132:135], a[184:187], a[72:75], v[132:135]
  ds_read_b64_tr_b16 a[206:207], v219 offset:28672
  ds_read_b64_tr_b16 a[208:209], v230 offset:40960
  v_mfma_f32_16x16x32_bf16 v[132:135], a[188:191], a[76:79], v[132:135]
  ds_read_b64_tr_b16 a[210:211], v230 offset:45056
  ds_read_b64_tr_b16 a[212:213], v231 offset:40960
  v_mfma_f32_16x16x32_bf16 v[136:139], a[160:163], a[80:83], v[164:167]
  ds_read_b64_tr_b16 a[214:215], v231 offset:45056
  ds_read_b64_tr_b16 a[216:217], v230 offset:57344
  v_mfma_f32_16x16x32_bf16 v[136:139], a[164:167], a[84:87], v[136:139]
  ds_read_b64_tr_b16 a[218:219], v230 offset:61440
  ds_read_b64_tr_b16 a[220:221], v231 offset:57344
  v_mfma_f32_16x16x32_bf16 v[136:139], a[168:171], a[88:91], v[136:139]
  ds_read_b64_tr_b16 a[222:223], v231 offset:61440
  ds_read_b128 a[16:19], v254
  v_mfma_f32_16x16x32_bf16 v[136:139], a[172:175], a[92:95], v[136:139]
  ds_read_b128 a[24:27], v254 offset:16384
  ds_read_b128 a[32:35], v254 offset:32768
  v_mfma_f32_16x16x32_bf16 v[140:143], a[176:179], a[80:83], v[164:167]
  ds_read_b128 a[40:43], v254 offset:49152
  ds_read_b128 a[20:23], v254 offset:1024
  v_mfma_f32_16x16x32_bf16 v[140:143], a[180:183], a[84:87], v[140:143]
  ds_read_b128 a[28:31], v254 offset:17408
  ds_read_b128 a[36:39], v254 offset:33792
  v_mfma_f32_16x16x32_bf16 v[140:143], a[184:187], a[88:91], v[140:143]
  ds_read_b128 a[44:47], v254 offset:50176
  v_mfma_f32_16x16x32_bf16 v[140:143], a[188:191], a[92:95], v[140:143]
  s_waitcnt lgkmcnt(7)
  v_mfma_f32_16x16x32_bf16 a[0:3], a[192:195], a[16:19], a[0:3]
  v_exp_f32 v128, v128
  v_mfma_f32_16x16x32_bf16 a[4:7], a[196:199], a[16:19], a[4:7]
  s_waitcnt lgkmcnt(6)
  v_mfma_f32_16x16x32_bf16 a[0:3], a[200:203], a[24:27], a[0:3]
  v_exp_f32 v129, v129
  v_mfma_f32_16x16x32_bf16 a[4:7], a[204:207], a[24:27], a[4:7]
  s_waitcnt lgkmcnt(5)
  v_mfma_f32_16x16x32_bf16 a[0:3], a[208:211], a[32:35], a[0:3]
  v_exp_f32 v130, v130
  v_mfma_f32_16x16x32_bf16 a[4:7], a[212:215], a[32:35], a[4:7]
  s_waitcnt lgkmcnt(4)
  v_mfma_f32_16x16x32_bf16 a[0:3], a[216:219], a[40:43], a[0:3]
  v_exp_f32 v131, v131
  v_mfma_f32_16x16x32_bf16 a[4:7], a[220:223], a[40:43], a[4:7]
  v_mfma_f32_16x16x32_bf16 v[200:203], a[224:227], v[144:147], v[200:203]
  s_waitcnt lgkmcnt(0)
  v_exp_f32 v132, v132
  v_mfma_f32_16x16x32_bf16 a[8:11], a[192:195], a[20:23], a[8:11]
  v_mfma_f32_16x16x32_bf16 a[12:15], a[196:199], a[20:23], a[12:15]
  v_exp_f32 v133, v133
  v_mfma_f32_16x16x32_bf16 a[8:11], a[200:203], a[28:31], a[8:11]
  ds_read_b64_tr_b16 a[192:193], v213 offset:8192
  ds_read_b64_tr_b16 a[194:195], v213 offset:12288
  v_mfma_f32_16x16x32_bf16 a[12:15], a[204:207], a[28:31], a[12:15]
  v_exp_f32 v134, v134
  v_mfma_f32_16x16x32_bf16 a[8:11], a[208:211], a[36:39], a[8:11]
  ds_read_b64_tr_b16 a[196:197], v216 offset:8192
  ds_read_b64_tr_b16 a[198:199], v216 offset:12288
  v_mfma_f32_16x16x32_bf16 a[12:15], a[212:215], a[36:39], a[12:15]
  v_exp_f32 v135, v135
  v_mfma_f32_16x16x32_bf16 a[8:11], a[216:219], a[44:47], a[8:11]
  ds_read_b64_tr_b16 a[200:201], v213 offset:8448
  ds_read_b64_tr_b16 a[202:203], v213 offset:12544
  v_mfma_f32_16x16x32_bf16 a[12:15], a[220:223], a[44:47], a[12:15]
  ds_read_b64_tr_b16 a[204:205], v216 offset:8448
  ds_read_b64_tr_b16 a[206:207], v216 offset:12544
  v_mfma_f32_16x16x32_bf16 v[204:207], a[224:227], v[152:155], v[204:207]
  v_mfma_f32_16x16x32_bf16 v[144:147], a[160:163], a[96:99], v[168:171]
  v_exp_f32 v136, v136
  v_mfma_f32_16x16x32_bf16 v[144:147], a[164:167], a[100:103], v[144:147]
  ds_read_b64_tr_b16 a[208:209], v213 offset:8704
  ds_read_b64_tr_b16 a[210:211], v213 offset:12800
  v_mfma_f32_16x16x32_bf16 v[144:147], a[168:171], a[104:107], v[144:147]
  v_exp_f32 v137, v137
  v_mfma_f32_16x16x32_bf16 v[144:147], a[172:175], a[108:111], v[144:147]
  ds_read_b64_tr_b16 a[212:213], v216 offset:8704
  ds_read_b64_tr_b16 a[214:215], v216 offset:12800
TP13:
  s_cbranch_execz L_TRET
  v_mfma_f32_16x16x32_bf16 v[148:151], a[176:179], a[96:99], v[168:171]
  v_exp_f32 v138, v138
  v_mfma_f32_16x16x32_bf16 v[148:151], a[180:183], a[100:103], v[148:151]
  ds_read_b64_tr_b16 a[216:217], v213 offset:8960
  ds_read_b64_tr_b16 a[218:219], v213 offset:13056
  v_mfma_f32_16x16x32_bf16 v[148:151], a[184:187], a[104:107], v[148:151]
  v_exp_f32 v139, v139
  v_mfma_f32_16x16x32_bf16 v[148:151], a[188:191], a[108:111], v[148:151]
  s_waitcnt vmcnt(8)
  s_barrier
  v_mfma_f32_16x16x32_bf16 v[152:155], a[160:163], a[112:115], v[172:175]
  v_exp_f32 v140, v140
  v_mfma_f32_16x16x32_bf16 v[152:155], a[164:167], a[116:119], v[152:155]
  ds_read_b64_tr_b16 a[220:221], v216 offset:8960
  ds_read_b64_tr_b16 a[222:223], v216 offset:13056
  v_mfma_f32_16x16x32_bf16 v[152:155], a[168:171], a[120:123], v[152:155]
  v_exp_f32 v141, v141
  v_mfma_f32_16x16x32_bf16 v[152:155], a[172:175], a[124:127], v[152:155]
  v_cvt_pk_bf16_f32 v128, v128, v129
  v_cvt_pk_bf16_f32 v129, v130, v131
  v_mfma_f32_16x16x32_bf16 v[156:159], a[176:179], a[112:115], v[172:175]
  v_exp_f32 v142, v142
  v_mfma_f32_16x16x32_bf16 v[156:159], a[180:183], a[116:119], v[156:159]
  v_cvt_pk_bf16_f32 v130, v132, v133
  v_cvt_pk_bf16_f32 v131, v134, v135
  v_mfma_f32_16x16x32_bf16 v[156:159], a[184:187], a[120:123], v[156:159]
  v_exp_f32 v143, v143
  v_mfma_f32_16x16x32_bf16 v[156:159], a[188:191], a[124:127], v[156:159]
  s_waitcnt lgkmcnt(2)
  v_cvt_pk_bf16_f32 v136, v136, v137
  v_cvt_pk_bf16_f32 v137, v138, v139
  v_mfma_f32_16x16x32_bf16 v[0:3], a[192:195], v[128:131], v[0:3]
  v_exp_f32 v144, v144
  v_mfma_f32_16x16x32_bf16 v[4:7], a[196:199], v[128:131], v[4:7]
  v_cvt_pk_bf16_f32 v138, v140, v141
  v_cvt_pk_bf16_f32 v139, v142, v143
  v_mfma_f32_16x16x32_bf16 v[8:11], a[200:203], v[128:131], v[8:11]
  v_exp_f32 v145, v145
  v_mfma_f32_16x16x32_bf16 v[12:15], a[204:207], v[128:131], v[12:15]
  ds_read_b128 a[160:163], v210 offset:16384
  ds_read_b128 a[164:167], v210 offset:16640
  v_mfma_f32_16x16x32_bf16 v[16:19], a[208:211], v[128:131], v[16:19]
  v_exp_f32 v146, v146
  v_mfma_f32_16x16x32_bf16 v[20:23], a[212:215], v[128:131], v[20:23]
  ds_read_b128 a[168:171], v210 offset:16896
  ds_read_b128 a[172:175], v210 offset:17152
  v_mfma_f32_16x16x32_bf16 v[24:27], a[216:219], v[128:131], v[24:27]
  s_waitcnt lgkmcnt(4)
  v_exp_f32 v147, v147
  v_mfma_f32_16x16x32_bf16 v[28:31], a[220:223], v[128:131], v[28:31]
  ds_read_b128 a[176:179], v210 offset:20480
  ds_read_b128 a[180:183], v210 offset:20736
  v_mfma_f32_16x16x32_bf16 v[184:187], a[224:227], v[128:131], v[184:187]
  v_exp_f32 v148, v148
  v_mfma_f32_16x16x32_bf16 v[32:35], a[192:195], v[136:139], v[32:35]
  ds_read_b128 a[184:187], v210 offset:20992
  ds_read_b128 a[188:191], v210 offset:21248
  v_mfma_f32_16x16x32_bf16 v[36:39], a[196:199], v[136:139], v[36:39]
  v_exp_f32 v149, v149
  v_mfma_f32_16x16x32_bf16 v[40:43], a[200:203], v[136:139], v[40:43]
  s_add_u32 m0, s29, 32768
  v_mfma_f32_16x16x32_bf16 v[44:47], a[204:207], v[136:139], v[44:47]
  v_exp_f32 v150, v150
  v_mfma_f32_16x16x32_bf16 v[48:51], a[208:211], v[136:139], v[48:51]
  buffer_load_dwordx4 v220, s[16:19], s76 offen nt lds
  v_mfma_f32_16x16x32_bf16 v[52:55], a[212:215], v[136:139], v[52:55]
  v_exp_f32 v151, v151
  v_mfma_f32_16x16x32_bf16 v[56:59], a[216:219], v[136:139], v[56:59]
  buffer_load_dwordx4 v221, s[16:19], s76 offen offset:1024 nt lds
  v_mfma_f32_16x16x32_bf16 v[60:63], a[220:223], v[136:139], v[60:63]
  v_mfma_f32_16x16x32_bf16 v[188:191], a[224:227], v[136:139], v[188:191]
  s_waitcnt lgkmcnt(2)
  v_mfma_f32_16x16x32_bf16 v[128:131], a[160:163], a[64:67], v[160:163]
  v_exp_f32 v152, v152
  v_mfma_f32_16x16x32_bf16 v[128:131], a[164:167], a[68:71], v[128:131]
  v_cvt_pk_bf16_f32 v144, v144, v145
  v_cvt_pk_bf16_f32 v145, v146, v147
  v_mfma_f32_16x16x32_bf16 v[128:131], a[168:171], a[72:75], v[128:131]
  v_exp_f32 v153, v153
  v_mfma_f32_16x16x32_bf16 v[128:131], a[172:175], a[76:79], v[128:131]
  v_cvt_pk_bf16_f32 v146, v148, v149
  v_cvt_pk_bf16_f32 v147, v150, v151
  v_mfma_f32_16x16x32_bf16 v[132:135], a[176:179], a[64:67], v[160:163]
  v_exp_f32 v154, v154
  v_mfma_f32_16x16x32_bf16 v[132:135], a[180:183], a[68:71], v[132:135]
  s_waitcnt lgkmcnt(0)
  s_add_u32 m0, s29, 40960
  v_cvt_pk_bf16_f32 v152, v152, v153
  v_mfma_f32_16x16x32_bf16 v[132:135], a[184:187], a[72:75], v[132:135]
  v_exp_f32 v155, v155
  v_mfma_f32_16x16x32_bf16 v[132:135], a[188:191], a[76:79], v[132:135]
  v_cvt_pk_bf16_f32 v153, v154, v155
  v_mfma_f32_16x16x32_bf16 v[136:139], a[160:163], a[80:83], v[164:167]
  v_exp_f32 v156, v156
  v_mfma_f32_16x16x32_bf16 v[136:139], a[164:167], a[84:87], v[136:139]
  buffer_load_dwordx4 v222, s[20:23], s76 offen nt lds
  v_mfma_f32_16x16x32_bf16 v[136:139], a[168:171], a[88:91], v[136:139]
  v_exp_f32 v157, v157
  v_mfma_f32_16x16x32_bf16 v[136:139], a[172:175], a[92:95], v[136:139]
  v_cvt_pk_bf16_f32 v154, v156, v157
  v_mfma_f32_16x16x32_bf16 v[140:143], a[176:179], a[80:83], v[164:167]
  v_exp_f32 v158, v158
  v_mfma_f32_16x16x32_bf16 v[140:143], a[180:183], a[84:87], v[140:143]
  buffer_load_dwordx4 v223, s[20:23], s76 offen offset:1024 nt lds
  v_mfma_f32_16x16x32_bf16 v[140:143], a[184:187], a[88:91], v[140:143]
  v_exp_f32 v159, v159
  v_mfma_f32_16x16x32_bf16 v[140:143], a[188:191], a[92:95], v[140:143]
  s_add_u32 m0, s29, 49152
  v_cvt_pk_bf16_f32 v155, v158, v159
  v_mfma_f32_16x16x32_bf16 v[64:67], a[192:195], v[144:147], v[64:67]
  v_exp_f32 v128, v128
  v_mfma_f32_16x16x32_bf16 v[68:71], a[196:199], v[144:147], v[68:71]
  buffer_load_dwordx4 v220, s[16:19], s77 offen nt lds
  v_mfma_f32_16x16x32_bf16 v[72:75], a[200:203], v[144:147], v[72:75]
  v_exp_f32 v129, v129
  v_mfma_f32_16x16x32_bf16 v[76:79], a[204:207], v[144:147], v[76:79]
  buffer_load_dwordx4 v221, s[16:19], s77 offen offset:1024 nt lds
  v_mfma_f32_16x16x32_bf16 v[80:83], a[208:211], v[144:147], v[80:83]
  v_exp_f32 v130, v130
  v_mfma_f32_16x16x32_bf16 v[84:87], a[212:215], v[144:147], v[84:87]
  v_mfma_f32_16x16x32_bf16 v[88:91], a[216:219], v[144:147], v[88:91]
  v_exp_f32 v131, v131
  v_mfma_f32_16x16x32_bf16 v[92:95], a[220:223], v[144:147], v[92:95]
  v_mfma_f32_16x16x32_bf16 v[192:195], a[224:227], v[144:147], v[192:195]
  v_exp_f32 v132, v132
  v_mfma_f32_16x16x32_bf16 v[96:99], a[192:195], v[152:155], v[96:99]
  v_mfma_f32_16x16x32_bf16 v[100:103], a[196:199], v[152:155], v[100:103]
  v_exp_f32 v133, v133
  v_mfma_f32_16x16x32_bf16 v[104:107], a[200:203], v[152:155], v[104:107]
  ds_read_b64_tr_b16 a[192:193], v213 offset:24576
  ds_read_b64_tr_b16 a[194:195], v213 offset:28672
  v_mfma_f32_16x16x32_bf16 v[108:111], a[204:207], v[152:155], v[108:111]
  v_exp_f32 v134, v134
  v_mfma_f32_16x16x32_bf16 v[112:115], a[208:211], v[152:155], v[112:115]
  ds_read_b64_tr_b16 a[196:197], v216 offset:24576
  ds_read_b64_tr_b16 a[198:199], v216 offset:28672
  v_mfma_f32_16x16x32_bf16 v[116:119], a[212:215], v[152:155], v[116:119]
  v_exp_f32 v135, v135
  v_mfma_f32_16x16x32_bf16 v[120:123], a[216:219], v[152:155], v[120:123]
  ds_read_b64_tr_b16 a[200:201], v213 offset:24832
  ds_read_b64_tr_b16 a[202:203], v213 offset:28928
  v_mfma_f32_16x16x32_bf16 v[124:127], a[220:223], v[152:155], v[124:127]
  ds_read_b64_tr_b16 a[204:205], v216 offset:24832
  ds_read_b64_tr_b16 a[206:207], v216 offset:28928
TP14:
  s_cbranch_execz L_TRET
  v_mfma_f32_16x16x32_bf16 v[196:199], a[224:227], v[152:155], v[196:199]
  v_mfma_f32_16x16x32_bf16 v[144:147], a[160:163], a[96:99], v[168:171]
  v_exp_f32 v136, v136
  v_mfma_f32_16x16x32_bf16 v[144:147], a[164:167], a[100:103], v[144:147]
  ds_read_b64_tr_b16 a[208:209], v213 offset:25088
  ds_read_b64_tr_b16 a[210:211], v213 offset:29184
  v_mfma_f32_16x16x32_bf16 v[144:147], a[168:171], a[104:107], v[144:147]
  v_exp_f32 v137, v137
  v_mfma_f32_16x16x32_bf16 v[144:147], a[172:175], a[108:111], v[144:147]
  ds_read_b64_tr_b16 a[212:213], v216 offset:25088
  ds_read_b64_tr_b16 a[214:215], v216 offset:29184
  v_mfma_f32_16x16x32_bf16 v[148:151], a[176:179], a[96:99], v[168:171]
  v_exp_f32 v138, v138
  v_mfma_f32_16x16x32_bf16 v[148:151], a[180:183], a[100:103], v[148:151]
  ds_read_b64_tr_b16 a[216:217], v213 offset:25344
  ds_read_b64_tr_b16 a[218:219], v213 offset:29440
  v_mfma_f32_16x16x32_bf16 v[148:151], a[184:187], a[104:107], v[148:151]
  v_exp_f32 v139, v139
  v_mfma_f32_16x16x32_bf16 v[148:151], a[188:191], a[108:111], v[148:151]
  s_waitcnt vmcnt(10)
  s_barrier
  v_mfma_f32_16x16x32_bf16 v[152:155], a[160:163], a[112:115], v[172:175]
  v_exp_f32 v140, v140
  v_mfma_f32_16x16x32_bf16 v[152:155], a[164:167], a[116:119], v[152:155]
  ds_read_b64_tr_b16 a[220:221], v216 offset:25344
  ds_read_b64_tr_b16 a[222:223], v216 offset:29440
  v_mfma_f32_16x16x32_bf16 v[152:155], a[168:171], a[120:123], v[152:155]
  v_exp_f32 v141, v141
  v_mfma_f32_16x16x32_bf16 v[152:155], a[172:175], a[124:127], v[152:155]
  v_cvt_pk_bf16_f32 v128, v128, v129
  v_cvt_pk_bf16_f32 v129, v130, v131
  v_mfma_f32_16x16x32_bf16 v[156:159], a[176:179], a[112:115], v[172:175]
  v_exp_f32 v142, v142
  v_mfma_f32_16x16x32_bf16 v[156:159], a[180:183], a[116:119], v[156:159]
  v_cvt_pk_bf16_f32 v130, v132, v133
  v_cvt_pk_bf16_f32 v131, v134, v135
  v_mfma_f32_16x16x32_bf16 v[156:159], a[184:187], a[120:123], v[156:159]
  v_exp_f32 v143, v143
  v_mfma_f32_16x16x32_bf16 v[156:159], a[188:191], a[124:127], v[156:159]
  s_waitcnt lgkmcnt(2)
  v_cvt_pk_bf16_f32 v136, v136, v137
  v_cvt_pk_bf16_f32 v137, v138, v139
  v_mfma_f32_16x16x32_bf16 v[0:3], a[192:195], v[128:131], v[0:3]
  v_exp_f32 v144, v144
  v_mfma_f32_16x16x32_bf16 v[4:7], a[196:199], v[128:131], v[4:7]
  v_cvt_pk_bf16_f32 v138, v140, v141
  v_cvt_pk_bf16_f32 v139, v142, v143
  v_mfma_f32_16x16x32_bf16 v[8:11], a[200:203], v[128:131], v[8:11]
  v_exp_f32 v145, v145
  v_mfma_f32_16x16x32_bf16 v[12:15], a[204:207], v[128:131], v[12:15]
  ds_read_b128 a[160:163], v208
  ds_read_b128 a[164:167], v208 offset:256
  v_mfma_f32_16x16x32_bf16 v[16:19], a[208:211], v[128:131], v[16:19]
  v_exp_f32 v146, v146
  v_mfma_f32_16x16x32_bf16 v[20:23], a[212:215], v[128:131], v[20:23]
  ds_read_b128 a[168:171], v208 offset:512
  ds_read_b128 a[172:175], v208 offset:768
  v_mfma_f32_16x16x32_bf16 v[24:27], a[216:219], v[128:131], v[24:27]
  s_waitcnt lgkmcnt(4)
  v_exp_f32 v147, v147
  v_mfma_f32_16x16x32_bf16 v[28:31], a[220:223], v[128:131], v[28:31]
  ds_read_b128 a[176:179], v208 offset:4096
  ds_read_b128 a[180:183], v208 offset:4352
  v_mfma_f32_16x16x32_bf16 v[184:187], a[224:227], v[128:131], v[184:187]
  v_exp_f32 v148, v148
  v_mfma_f32_16x16x32_bf16 v[32:35], a[192:195], v[136:139], v[32:35]
  ds_read_b128 a[184:187], v208 offset:4608
  ds_read_b128 a[188:191], v208 offset:4864
  v_mfma_f32_16x16x32_bf16 v[36:39], a[196:199], v[136:139], v[36:39]
  v_exp_f32 v149, v149
  v_mfma_f32_16x16x32_bf16 v[40:43], a[200:203], v[136:139], v[40:43]
  v_mfma_f32_16x16x32_bf16 v[44:47], a[204:207], v[136:139], v[44:47]
  v_exp_f32 v150, v150
  v_mfma_f32_16x16x32_bf16 v[48:51], a[208:211], v[136:139], v[48:51]
  v_mfma_f32_16x16x32_bf16 v[52:55], a[212:215], v[136:139], v[52:55]
  v_exp_f32 v151, v151
  v_mfma_f32_16x16x32_bf16 v[56:59], a[216:219], v[136:139], v[56:59]
  v_mfma_f32_16x16x32_bf16 v[60:63], a[220:223], v[136:139], v[60:63]
  v_mfma_f32_16x16x32_bf16 v[188:191], a[224:227], v[136:139], v[188:191]
  s_waitcnt lgkmcnt(2)
  v_mfma_f32_16x16x32_bf16 v[128:131], a[160:163], a[64:67], v[160:163]
  v_exp_f32 v152, v152
  v_mfma_f32_16x16x32_bf16 v[128:131], a[164:167], a[68:71], v[128:131]
  v_cvt_pk_bf16_f32 v144, v144, v145
  v_cvt_pk_bf16_f32 v145, v146, v147
  v_mfma_f32_16x16x32_bf16 v[128:131], a[168:171], a[72:75], v[128:131]
  v_exp_f32 v153, v153
  v_mfma_f32_16x16x32_bf16 v[128:131], a[172:175], a[76:79], v[128:131]
  v_cvt_pk_bf16_f32 v146, v148, v149
  v_cvt_pk_bf16_f32 v147, v150, v151
  v_mfma_f32_16x16x32_bf16 v[132:135], a[176:179], a[64:67], v[160:163]
  v_exp_f32 v154, v154
  v_mfma_f32_16x16x32_bf16 v[132:135], a[180:183], a[68:71], v[132:135]
  s_waitcnt lgkmcnt(0)
  s_add_u32 m0, s29, 57344
  v_cvt_pk_bf16_f32 v152, v152, v153
  v_mfma_f32_16x16x32_bf16 v[132:135], a[184:187], a[72:75], v[132:135]
  v_exp_f32 v155, v155
  v_mfma_f32_16x16x32_bf16 v[132:135], a[188:191], a[76:79], v[132:135]
  v_cvt_pk_bf16_f32 v153, v154, v155
  v_mfma_f32_16x16x32_bf16 v[136:139], a[160:163], a[80:83], v[164:167]
  v_exp_f32 v156, v156
  v_mfma_f32_16x16x32_bf16 v[136:139], a[164:167], a[84:87], v[136:139]
  buffer_load_dwordx4 v222, s[20:23], s77 offen nt lds
  v_mfma_f32_16x16x32_bf16 v[136:139], a[168:171], a[88:91], v[136:139]
  v_exp_f32 v157, v157
  v_mfma_f32_16x16x32_bf16 v[136:139], a[172:175], a[92:95], v[136:139]
  v_cvt_pk_bf16_f32 v154, v156, v157
  v_mfma_f32_16x16x32_bf16 v[140:143], a[176:179], a[80:83], v[164:167]
  v_exp_f32 v158, v158
  v_mfma_f32_16x16x32_bf16 v[140:143], a[180:183], a[84:87], v[140:143]
  buffer_load_dwordx4 v223, s[20:23], s77 offen offset:1024 nt lds
  v_mfma_f32_16x16x32_bf16 v[140:143], a[184:187], a[88:91], v[140:143]
  v_exp_f32 v159, v159
  v_mfma_f32_16x16x32_bf16 v[140:143], a[188:191], a[92:95], v[140:143]
  s_add_u32 m0, s29, 65536
  v_cvt_pk_bf16_f32 v155, v158, v159
  v_mfma_f32_16x16x32_bf16 v[64:67], a[192:195], v[144:147], v[64:67]
  v_exp_f32 v128, v128
  v_mfma_f32_16x16x32_bf16 v[68:71], a[196:199], v[144:147], v[68:71]
  buffer_load_dwordx4 v220, s[16:19], s78 offen nt lds
  v_mfma_f32_16x16x32_bf16 v[72:75], a[200:203], v[144:147], v[72:75]
  v_exp_f32 v129, v129
  v_mfma_f32_16x16x32_bf16 v[76:79], a[204:207], v[144:147], v[76:79]
  buffer_load_dwordx4 v221, s[16:19], s78 offen offset:1024 nt lds
  v_mfma_f32_16x16x32_bf16 v[80:83], a[208:211], v[144:147], v[80:83]
  v_exp_f32 v130, v130
  v_mfma_f32_16x16x32_bf16 v[84:87], a[212:215], v[144:147], v[84:87]
  s_add_u32 m0, s29, 73728
  v_mfma_f32_16x16x32_bf16 v[88:91], a[216:219], v[144:147], v[88:91]
  v_exp_f32 v131, v131
  v_mfma_f32_16x16x32_bf16 v[92:95], a[220:223], v[144:147], v[92:95]
  buffer_load_dwordx4 v222, s[20:23], s78 offen nt lds
  v_mfma_f32_16x16x32_bf16 v[192:195], a[224:227], v[144:147], v[192:195]
  v_exp_f32 v132, v132
  v_mfma_f32_16x16x32_bf16 v[96:99], a[192:195], v[152:155], v[96:99]
  buffer_load_dwordx4 v223, s[20:23], s78 offen offset:1024 nt lds
  v_mfma_f32_16x16x32_bf16 v[100:103], a[196:199], v[152:155], v[100:103]
  v_exp_f32 v133, v133
  v_mfma_f32_16x16x32_bf16 v[104:107], a[200:203], v[152:155], v[104:107]
  ds_read_b64_tr_b16 a[192:193], v211 offset:8192
  ds_read_b64_tr_b16 a[194:195], v211 offset:12288
  v_mfma_f32_16x16x32_bf16 v[108:111], a[204:207], v[152:155], v[108:111]
  v_exp_f32 v134, v134
  v_mfma_f32_16x16x32_bf16 v[112:115], a[208:211], v[152:155], v[112:115]
  ds_read_b64_tr_b16 a[196:197], v214 offset:8192
  ds_read_b64_tr_b16 a[198:199], v214 offset:12288
TP15:
  s_cbranch_execz L_TRET
  v_mfma_f32_16x16x32_bf16 v[116:119], a[212:215], v[152:155], v[116:119]
  v_exp_f32 v135, v135
  v_mfma_f32_16x16x32_bf16 v[120:123], a[216:219], v[152:155], v[120:123]
  ds_read_b64_tr_b16 a[200:201], v211 offset:8448
  ds_read_b64_tr_b16 a[202:203], v211 offset:12544
  v_mfma_f32_16x16x32_bf16 v[124:127], a[220:223], v[152:155], v[124:127]
  ds_read_b64_tr_b16 a[204:205], v214 offset:8448
  ds_read_b64_tr_b16 a[206:207], v214 offset:12544
  v_mfma_f32_16x16x32_bf16 v[196:199], a[224:227], v[152:155], v[196:199]
  v_mfma_f32_16x16x32_bf16 v[144:147], a[160:163], a[96:99], v[168:171]
  v_exp_f32 v136, v136
  v_mfma_f32_16x16x32_bf16 v[144:147], a[164:167], a[100:103], v[144:147]
  ds_read_b64_tr_b16 a[208:209], v211 offset:8704
  ds_read_b64_tr_b16 a[210:211], v211 offset:12800
  v_mfma_f32_16x16x32_bf16 v[144:147], a[168:171], a[104:107], v[144:147]
  v_exp_f32 v137, v137
  v_mfma_f32_16x16x32_bf16 v[144:147], a[172:175], a[108:111], v[144:147]
  ds_read_b64_tr_b16 a[212:213], v214 offset:8704
  ds_read_b64_tr_b16 a[214:215], v214 offset:12800
  v_mfma_f32_16x16x32_bf16 v[148:151], a[176:179], a[96:99], v[168:171]
  v_exp_f32 v138, v138
  v_mfma_f32_16x16x32_bf16 v[148:151], a[180:183], a[100:103], v[148:151]
  ds_read_b64_tr_b16 a[216:217], v211 offset:8960
  ds_read_b64_tr_b16 a[218:219], v211 offset:13056
  v_mfma_f32_16x16x32_bf16 v[148:151], a[184:187], a[104:107], v[148:151]
  v_exp_f32 v139, v139
  v_mfma_f32_16x16x32_bf16 v[148:151], a[188:191], a[108:111], v[148:151]
  s_waitcnt vmcnt(12)
  s_barrier
  v_mfma_f32_16x16x32_bf16 v[152:155], a[160:163], a[112:115], v[172:175]
  v_exp_f32 v140, v140
  v_mfma_f32_16x16x32_bf16 v[152:155], a[164:167], a[116:119], v[152:155]
  ds_read_b64_tr_b16 a[220:221], v214 offset:8960
  ds_read_b64_tr_b16 a[222:223], v214 offset:13056
  v_mfma_f32_16x16x32_bf16 v[152:155], a[168:171], a[120:123], v[152:155]
  v_exp_f32 v141, v141
  v_mfma_f32_16x16x32_bf16 v[152:155], a[172:175], a[124:127], v[152:155]
  v_cvt_pk_bf16_f32 v128, v128, v129
  v_cvt_pk_bf16_f32 v129, v130, v131
  v_mfma_f32_16x16x32_bf16 v[156:159], a[176:179], a[112:115], v[172:175]
  v_exp_f32 v142, v142
  v_mfma_f32_16x16x32_bf16 v[156:159], a[180:183], a[116:119], v[156:159]
  v_cvt_pk_bf16_f32 v130, v132, v133
  v_cvt_pk_bf16_f32 v131, v134, v135
  v_mfma_f32_16x16x32_bf16 v[156:159], a[184:187], a[120:123], v[156:159]
  v_exp_f32 v143, v143
  v_mfma_f32_16x16x32_bf16 v[156:159], a[188:191], a[124:127], v[156:159]
  s_waitcnt lgkmcnt(2)
  v_cvt_pk_bf16_f32 v136, v136, v137
  v_cvt_pk_bf16_f32 v137, v138, v139
  v_mfma_f32_16x16x32_bf16 v[0:3], a[192:195], v[128:131], v[0:3]
  v_exp_f32 v144, v144
  v_mfma_f32_16x16x32_bf16 v[4:7], a[196:199], v[128:131], v[4:7]
  v_cvt_pk_bf16_f32 v138, v140, v141
  v_cvt_pk_bf16_f32 v139, v142, v143
  v_mfma_f32_16x16x32_bf16 v[8:11], a[200:203], v[128:131], v[8:11]
  v_exp_f32 v145, v145
  v_mfma_f32_16x16x32_bf16 v[12:15], a[204:207], v[128:131], v[12:15]
  ds_read_b128 a[160:163], v208 offset:16384
  ds_read_b128 a[164:167], v208 offset:16640
  v_mfma_f32_16x16x32_bf16 v[16:19], a[208:211], v[128:131], v[16:19]
  v_exp_f32 v146, v146
  v_mfma_f32_16x16x32_bf16 v[20:23], a[212:215], v[128:131], v[20:23]
  ds_read_b128 a[168:171], v208 offset:16896
  ds_read_b128 a[172:175], v208 offset:17152
  v_mfma_f32_16x16x32_bf16 v[24:27], a[216:219], v[128:131], v[24:27]
  s_waitcnt lgkmcnt(4)
  v_exp_f32 v147, v147
  v_mfma_f32_16x16x32_bf16 v[28:31], a[220:223], v[128:131], v[28:31]
  ds_read_b128 a[176:179], v208 offset:20480
  ds_read_b128 a[180:183], v208 offset:20736
  v_mfma_f32_16x16x32_bf16 v[184:187], a[224:227], v[128:131], v[184:187]
  v_exp_f32 v148, v148
  v_mfma_f32_16x16x32_bf16 v[32:35], a[192:195], v[136:139], v[32:35]
  ds_read_b128 a[184:187], v208 offset:20992
  ds_read_b128 a[188:191], v208 offset:21248
  v_mfma_f32_16x16x32_bf16 v[36:39], a[196:199], v[136:139], v[36:39]
  v_exp_f32 v149, v149
  v_mfma_f32_16x16x32_bf16 v[40:43], a[200:203], v[136:139], v[40:43]
  s_add_u32 m0, s29, 81920
  v_mfma_f32_16x16x32_bf16 v[44:47], a[204:207], v[136:139], v[44:47]
  v_exp_f32 v150, v150
  v_mfma_f32_16x16x32_bf16 v[48:51], a[208:211], v[136:139], v[48:51]
  buffer_load_dwordx4 v220, s[16:19], s79 offen nt lds
  v_mfma_f32_16x16x32_bf16 v[52:55], a[212:215], v[136:139], v[52:55]
  v_exp_f32 v151, v151
  v_mfma_f32_16x16x32_bf16 v[56:59], a[216:219], v[136:139], v[56:59]
  buffer_load_dwordx4 v221, s[16:19], s79 offen offset:1024 nt lds
  v_mfma_f32_16x16x32_bf16 v[60:63], a[220:223], v[136:139], v[60:63]
  v_mfma_f32_16x16x32_bf16 v[188:191], a[224:227], v[136:139], v[188:191]
  s_waitcnt lgkmcnt(2)
  v_mfma_f32_16x16x32_bf16 v[128:131], a[160:163], a[64:67], v[160:163]
  v_exp_f32 v152, v152
  v_mfma_f32_16x16x32_bf16 v[128:131], a[164:167], a[68:71], v[128:131]
  v_cvt_pk_bf16_f32 v144, v144, v145
  v_cvt_pk_bf16_f32 v145, v146, v147
  v_mfma_f32_16x16x32_bf16 v[128:131], a[168:171], a[72:75], v[128:131]
  v_exp_f32 v153, v153
  v_mfma_f32_16x16x32_bf16 v[128:131], a[172:175], a[76:79], v[128:131]
  v_cvt_pk_bf16_f32 v146, v148, v149
  v_cvt_pk_bf16_f32 v147, v150, v151
  v_mfma_f32_16x16x32_bf16 v[132:135], a[176:179], a[64:67], v[160:163]
  v_exp_f32 v154, v154
  v_mfma_f32_16x16x32_bf16 v[132:135], a[180:183], a[68:71], v[132:135]
  s_waitcnt lgkmcnt(0)
  s_add_u32 m0, s29, 90112
  v_cvt_pk_bf16_f32 v152, v152, v153
  v_mfma_f32_16x16x32_bf16 v[132:135], a[184:187], a[72:75], v[132:135]
  v_exp_f32 v155, v155
  v_mfma_f32_16x16x32_bf16 v[132:135], a[188:191], a[76:79], v[132:135]
  v_cvt_pk_bf16_f32 v153, v154, v155
  v_mfma_f32_16x16x32_bf16 v[136:139], a[160:163], a[80:83], v[164:167]
  v_exp_f32 v156, v156
  v_mfma_f32_16x16x32_bf16 v[136:139], a[164:167], a[84:87], v[136:139]
  buffer_load_dwordx4 v222, s[20:23], s79 offen nt lds
  v_mfma_f32_16x16x32_bf16 v[136:139], a[168:171], a[88:91], v[136:139]
  v_exp_f32 v157, v157
  v_mfma_f32_16x16x32_bf16 v[136:139], a[172:175], a[92:95], v[136:139]
  v_cvt_pk_bf16_f32 v154, v156, v157
  v_mfma_f32_16x16x32_bf16 v[140:143], a[176:179], a[80:83], v[164:167]
  v_exp_f32 v158, v158
  v_mfma_f32_16x16x32_bf16 v[140:143], a[180:183], a[84:87], v[140:143]
  buffer_load_dwordx4 v223, s[20:23], s79 offen offset:1024 nt lds
  v_mfma_f32_16x16x32_bf16 v[140:143], a[184:187], a[88:91], v[140:143]
  v_exp_f32 v159, v159
  v_mfma_f32_16x16x32_bf16 v[140:143], a[188:191], a[92:95], v[140:143]
  v_cvt_pk_bf16_f32 v155, v158, v159
  v_mfma_f32_16x16x32_bf16 v[64:67], a[192:195], v[144:147], v[64:67]
  v_exp_f32 v128, v128
  v_mfma_f32_16x16x32_bf16 v[68:71], a[196:199], v[144:147], v[68:71]
  v_mfma_f32_16x16x32_bf16 v[72:75], a[200:203], v[144:147], v[72:75]
  v_exp_f32 v129, v129
  v_mfma_f32_16x16x32_bf16 v[76:79], a[204:207], v[144:147], v[76:79]
  v_mfma_f32_16x16x32_bf16 v[80:83], a[208:211], v[144:147], v[80:83]
  v_exp_f32 v130, v130
  v_mfma_f32_16x16x32_bf16 v[84:87], a[212:215], v[144:147], v[84:87]
  v_mfma_f32_16x16x32_bf16 v[88:91], a[216:219], v[144:147], v[88:91]
  v_exp_f32 v131, v131
  v_mfma_f32_16x16x32_bf16 v[92:95], a[220:223], v[144:147], v[92:95]
  v_mfma_f32_16x16x32_bf16 v[192:195], a[224:227], v[144:147], v[192:195]
  v_exp_f32 v132, v132
  v_mfma_f32_16x16x32_bf16 v[96:99], a[192:195], v[152:155], v[96:99]
  v_mfma_f32_16x16x32_bf16 v[100:103], a[196:199], v[152:155], v[100:103]
  v_exp_f32 v133, v133
TP16:
  s_cbranch_execz L_TRET
  v_mfma_f32_16x16x32_bf16 v[104:107], a[200:203], v[152:155], v[104:107]
  ds_read_b64_tr_b16 a[192:193], v211 offset:24576
  ds_read_b64_tr_b16 a[194:195], v211 offset:28672
  v_mfma_f32_16x16x32_bf16 v[108:111], a[204:207], v[152:155], v[108:111]
  v_exp_f32 v134, v134
  v_mfma_f32_16x16x32_bf16 v[112:115], a[208:211], v[152:155], v[112:115]
  ds_read_b64_tr_b16 a[196:197], v214 offset:24576
  ds_read_b64_tr_b16 a[198:199], v214 offset:28672
  v_mfma_f32_16x16x32_bf16 v[116:119], a[212:215], v[152:155], v[116:119]
  v_exp_f32 v135, v135
  v_mfma_f32_16x16x32_bf16 v[120:123], a[216:219], v[152:155], v[120:123]
  ds_read_b64_tr_b16 a[200:201], v211 offset:24832
  ds_read_b64_tr_b16 a[202:203], v211 offset:28928
  v_mfma_f32_16x16x32_bf16 v[124:127], a[220:223], v[152:155], v[124:127]
  ds_read_b64_tr_b16 a[204:205], v214 offset:24832
  ds_read_b64_tr_b16 a[206:207], v214 offset:28928
  v_mfma_f32_16x16x32_bf16 v[196:199], a[224:227], v[152:155], v[196:199]
  v_mfma_f32_16x16x32_bf16 v[144:147], a[160:163], a[96:99], v[168:171]
  v_exp_f32 v136, v136
  v_mfma_f32_16x16x32_bf16 v[144:147], a[164:167], a[100:103], v[144:147]
  ds_read_b64_tr_b16 a[208:209], v211 offset:25088
  ds_read_b64_tr_b16 a[210:211], v211 offset:29184
  v_mfma_f32_16x16x32_bf16 v[144:147], a[168:171], a[104:107], v[144:147]
  v_exp_f32 v137, v137
  v_mfma_f32_16x16x32_bf16 v[144:147], a[172:175], a[108:111], v[144:147]
  ds_read_b64_tr_b16 a[212:213], v214 offset:25088
  ds_read_b64_tr_b16 a[214:215], v214 offset:29184
  v_mfma_f32_16x16x32_bf16 v[148:151], a[176:179], a[96:99], v[168:171]
  v_exp_f32 v138, v138
  v_mfma_f32_16x16x32_bf16 v[148:151], a[180:183], a[100:103], v[148:151]
  ds_read_b64_tr_b16 a[216:217], v211 offset:25344
  ds_read_b64_tr_b16 a[218:219], v211 offset:29440
  v_mfma_f32_16x16x32_bf16 v[148:151], a[184:187], a[104:107], v[148:151]
  v_exp_f32 v139, v139
  v_mfma_f32_16x16x32_bf16 v[148:151], a[188:191], a[108:111], v[148:151]
  s_waitcnt vmcnt(12)
  s_barrier
  v_mfma_f32_16x16x32_bf16 v[152:155], a[160:163], a[112:115], v[172:175]
  v_exp_f32 v140, v140
  v_mfma_f32_16x16x32_bf16 v[152:155], a[164:167], a[116:119], v[152:155]
  ds_read_b64_tr_b16 a[220:221], v214 offset:25344
  ds_read_b64_tr_b16 a[222:223], v214 offset:29440
  v_mfma_f32_16x16x32_bf16 v[152:155], a[168:171], a[120:123], v[152:155]
  v_exp_f32 v141, v141
  v_mfma_f32_16x16x32_bf16 v[152:155], a[172:175], a[124:127], v[152:155]
  v_cvt_pk_bf16_f32 v128, v128, v129
  v_cvt_pk_bf16_f32 v129, v130, v131
  v_mfma_f32_16x16x32_bf16 v[156:159], a[176:179], a[112:115], v[172:175]
  v_exp_f32 v142, v142
  v_mfma_f32_16x16x32_bf16 v[156:159], a[180:183], a[116:119], v[156:159]
  v_cvt_pk_bf16_f32 v130, v132, v133
  v_cvt_pk_bf16_f32 v131, v134, v135
  v_mfma_f32_16x16x32_bf16 v[156:159], a[184:187], a[120:123], v[156:159]
  v_exp_f32 v143, v143
  v_mfma_f32_16x16x32_bf16 v[156:159], a[188:191], a[124:127], v[156:159]
  s_waitcnt lgkmcnt(2)
  v_cvt_pk_bf16_f32 v136, v136, v137
  v_cvt_pk_bf16_f32 v137, v138, v139
  v_mfma_f32_16x16x32_bf16 v[0:3], a[192:195], v[128:131], v[0:3]
  v_exp_f32 v144, v144
  v_mfma_f32_16x16x32_bf16 v[4:7], a[196:199], v[128:131], v[4:7]
  v_cvt_pk_bf16_f32 v138, v140, v141
  v_cvt_pk_bf16_f32 v139, v142, v143
  v_mfma_f32_16x16x32_bf16 v[8:11], a[200:203], v[128:131], v[8:11]
  v_exp_f32 v145, v145
  v_mfma_f32_16x16x32_bf16 v[12:15], a[204:207], v[128:131], v[12:15]
  ds_read_b128 a[160:163], v208 offset:32768
  ds_read_b128 a[164:167], v208 offset:33024
  v_mfma_f32_16x16x32_bf16 v[16:19], a[208:211], v[128:131], v[16:19]
  v_exp_f32 v146, v146
  v_mfma_f32_16x16x32_bf16 v[20:23], a[212:215], v[128:131], v[20:23]
  ds_read_b128 a[168:171], v208 offset:33280
  ds_read_b128 a[172:175], v208 offset:33536
  v_mfma_f32_16x16x32_bf16 v[24:27], a[216:219], v[128:131], v[24:27]
  s_waitcnt lgkmcnt(4)
  v_exp_f32 v147, v147
  v_mfma_f32_16x16x32_bf16 v[28:31], a[220:223], v[128:131], v[28:31]
  ds_read_b128 a[176:179], v208 offset:36864
  ds_read_b128 a[180:183], v208 offset:37120
  v_mfma_f32_16x16x32_bf16 v[184:187], a[224:227], v[128:131], v[184:187]
  v_exp_f32 v148, v148
  v_mfma_f32_16x16x32_bf16 v[32:35], a[192:195], v[136:139], v[32:35]
  ds_read_b128 a[184:187], v208 offset:37376
  ds_read_b128 a[188:191], v208 offset:37632
  v_mfma_f32_16x16x32_bf16 v[36:39], a[196:199], v[136:139], v[36:39]
  v_exp_f32 v149, v149
  v_mfma_f32_16x16x32_bf16 v[40:43], a[200:203], v[136:139], v[40:43]
  v_mfma_f32_16x16x32_bf16 v[44:47], a[204:207], v[136:139], v[44:47]
  v_exp_f32 v150, v150
  v_mfma_f32_16x16x32_bf16 v[48:51], a[208:211], v[136:139], v[48:51]
  v_mfma_f32_16x16x32_bf16 v[52:55], a[212:215], v[136:139], v[52:55]
  v_exp_f32 v151, v151
  v_mfma_f32_16x16x32_bf16 v[56:59], a[216:219], v[136:139], v[56:59]
  v_mfma_f32_16x16x32_bf16 v[60:63], a[220:223], v[136:139], v[60:63]
  v_mfma_f32_16x16x32_bf16 v[188:191], a[224:227], v[136:139], v[188:191]
  s_waitcnt lgkmcnt(2)
  v_mfma_f32_16x16x32_bf16 v[128:131], a[160:163], a[64:67], v[160:163]
  v_exp_f32 v152, v152
  v_mfma_f32_16x16x32_bf16 v[128:131], a[164:167], a[68:71], v[128:131]
  v_cvt_pk_bf16_f32 v144, v144, v145
  v_cvt_pk_bf16_f32 v145, v146, v147
  v_mfma_f32_16x16x32_bf16 v[128:131], a[168:171], a[72:75], v[128:131]
  v_exp_f32 v153, v153
  v_mfma_f32_16x16x32_bf16 v[128:131], a[172:175], a[76:79], v[128:131]
  v_cvt_pk_bf16_f32 v146, v148, v149
  v_cvt_pk_bf16_f32 v147, v150, v151
  v_mfma_f32_16x16x32_bf16 v[132:135], a[176:179], a[64:67], v[160:163]
  v_exp_f32 v154, v154
  v_mfma_f32_16x16x32_bf16 v[132:135], a[180:183], a[68:71], v[132:135]
  s_waitcnt lgkmcnt(0)
  v_cvt_pk_bf16_f32 v152, v152, v153
  v_mfma_f32_16x16x32_bf16 v[132:135], a[184:187], a[72:75], v[132:135]
  v_exp_f32 v155, v155
  v_mfma_f32_16x16x32_bf16 v[132:135], a[188:191], a[76:79], v[132:135]
  s_waitcnt vmcnt(8)
  s_barrier
  v_mfma_f32_16x16x32_bf16 v[136:139], a[160:163], a[80:83], v[164:167]
  v_exp_f32 v156, v156
  v_mfma_f32_16x16x32_bf16 v[136:139], a[164:167], a[84:87], v[136:139]
  ds_read_b128 a[160:163], v208 offset:49152
  v_cvt_pk_bf16_f32 v153, v154, v155
  v_mfma_f32_16x16x32_bf16 v[136:139], a[168:171], a[88:91], v[136:139]
  v_exp_f32 v157, v157
  v_mfma_f32_16x16x32_bf16 v[136:139], a[172:175], a[92:95], v[136:139]
  ds_read_b128 a[164:167], v208 offset:49408
  v_cvt_pk_bf16_f32 v154, v156, v157
  v_mfma_f32_16x16x32_bf16 v[140:143], a[176:179], a[80:83], v[164:167]
  v_exp_f32 v158, v158
  v_mfma_f32_16x16x32_bf16 v[140:143], a[180:183], a[84:87], v[140:143]
  ds_read_b128 a[168:171], v208 offset:49664
  ds_read_b128 a[172:175], v208 offset:49920
  v_mfma_f32_16x16x32_bf16 v[140:143], a[184:187], a[88:91], v[140:143]
  v_exp_f32 v159, v159
  v_mfma_f32_16x16x32_bf16 v[140:143], a[188:191], a[92:95], v[140:143]
  ds_read_b128 a[176:179], v208 offset:53248
  v_cvt_pk_bf16_f32 v155, v158, v159
  v_mfma_f32_16x16x32_bf16 v[64:67], a[192:195], v[144:147], v[64:67]
  v_exp_f32 v128, v128
  v_mfma_f32_16x16x32_bf16 v[68:71], a[196:199], v[144:147], v[68:71]
  ds_read_b128 a[180:183], v208 offset:53504
  ds_read_b128 a[184:187], v208 offset:53760
  v_mfma_f32_16x16x32_bf16 v[72:75], a[200:203], v[144:147], v[72:75]
  v_exp_f32 v129, v129
  v_mfma_f32_16x16x32_bf16 v[76:79], a[204:207], v[144:147], v[76:79]
  ds_read_b128 a[188:191], v208 offset:54016
  v_mfma_f32_16x16x32_bf16 v[80:83], a[208:211], v[144:147], v[80:83]
  v_exp_f32 v130, v130
TP17:
  s_cbranch_execz L_TRET
  v_mfma_f32_16x16x32_bf16 v[84:87], a[212:215], v[144:147], v[84:87]
  v_mfma_f32_16x16x32_bf16 v[88:91], a[216:219], v[144:147], v[88:91]
  v_exp_f32 v131, v131
  v_mfma_f32_16x16x32_bf16 v[92:95], a[220:223], v[144:147], v[92:95]
  v_mfma_f32_16x16x32_bf16 v[192:195], a[224:227], v[144:147], v[192:195]
  v_exp_f32 v132, v132
  v_mfma_f32_16x16x32_bf16 v[96:99], a[192:195], v[152:155], v[96:99]
  v_mfma_f32_16x16x32_bf16 v[100:103], a[196:199], v[152:155], v[100:103]
  v_exp_f32 v133, v133
  v_mfma_f32_16x16x32_bf16 v[104:107], a[200:203], v[152:155], v[104:107]
  ds_read_b64_tr_b16 a[192:193], v211 offset:40960
  ds_read_b64_tr_b16 a[194:195], v211 offset:45056
  v_mfma_f32_16x16x32_bf16 v[108:111], a[204:207], v[152:155], v[108:111]
  v_exp_f32 v134, v134
  v_mfma_f32_16x16x32_bf16 v[112:115], a[208:211], v[152:155], v[112:115]
  ds_read_b64_tr_b16 a[196:197], v214 offset:40960
  ds_read_b64_tr_b16 a[198:199], v214 offset:45056
  v_mfma_f32_16x16x32_bf16 v[116:119], a[212:215], v[152:155], v[116:119]
  v_exp_f32 v135, v135
  v_mfma_f32_16x16x32_bf16 v[120:123], a[216:219], v[152:155], v[120:123]
  ds_read_b64_tr_b16 a[200:201], v211 offset:41216
  ds_read_b64_tr_b16 a[202:203], v211 offset:45312
  v_mfma_f32_16x16x32_bf16 v[124:127], a[220:223], v[152:155], v[124:127]
  ds_read_b64_tr_b16 a[204:205], v214 offset:41216
  ds_read_b64_tr_b16 a[206:207], v214 offset:45312
  v_mfma_f32_16x16x32_bf16 v[196:199], a[224:227], v[152:155], v[196:199]
  s_waitcnt lgkmcnt(8)
  v_mfma_f32_16x16x32_bf16 v[144:147], a[160:163], a[64:67], v[160:163]
  v_exp_f32 v136, v136
  v_mfma_f32_16x16x32_bf16 v[144:147], a[164:167], a[68:71], v[144:147]
  ds_read_b64_tr_b16 a[208:209], v211 offset:41472
  ds_read_b64_tr_b16 a[210:211], v211 offset:45568
  v_mfma_f32_16x16x32_bf16 v[144:147], a[168:171], a[72:75], v[144:147]
  v_exp_f32 v137, v137
  v_mfma_f32_16x16x32_bf16 v[144:147], a[172:175], a[76:79], v[144:147]
  ds_read_b64_tr_b16 a[212:213], v214 offset:41472
  ds_read_b64_tr_b16 a[214:215], v214 offset:45568
  v_mfma_f32_16x16x32_bf16 v[148:151], a[176:179], a[64:67], v[160:163]
  v_exp_f32 v138, v138
  v_mfma_f32_16x16x32_bf16 v[148:151], a[180:183], a[68:71], v[148:151]
  ds_read_b64_tr_b16 a[216:217], v211 offset:41728
  ds_read_b64_tr_b16 a[218:219], v211 offset:45824
  v_mfma_f32_16x16x32_bf16 v[148:151], a[184:187], a[72:75], v[148:151]
  v_exp_f32 v139, v139
  v_mfma_f32_16x16x32_bf16 v[148:151], a[188:191], a[76:79], v[148:151]
  s_waitcnt vmcnt(4)
  s_barrier
  v_mfma_f32_16x16x32_bf16 v[152:155], a[160:163], a[80:83], v[164:167]
  v_exp_f32 v140, v140
  v_mfma_f32_16x16x32_bf16 v[152:155], a[164:167], a[84:87], v[152:155]
  ds_read_b64_tr_b16 a[220:221], v214 offset:41728
  ds_read_b64_tr_b16 a[222:223], v214 offset:45824
  v_mfma_f32_16x16x32_bf16 v[152:155], a[168:171], a[88:91], v[152:155]
  v_exp_f32 v141, v141
  v_mfma_f32_16x16x32_bf16 v[152:155], a[172:175], a[92:95], v[152:155]
  v_cvt_pk_bf16_f32 v128, v128, v129
  v_cvt_pk_bf16_f32 v129, v130, v131
  v_mfma_f32_16x16x32_bf16 v[156:159], a[176:179], a[80:83], v[164:167]
  v_exp_f32 v142, v142
  v_mfma_f32_16x16x32_bf16 v[156:159], a[180:183], a[84:87], v[156:159]
  v_cvt_pk_bf16_f32 v130, v132, v133
  v_cvt_pk_bf16_f32 v131, v134, v135
  v_mfma_f32_16x16x32_bf16 v[156:159], a[184:187], a[88:91], v[156:159]
  v_exp_f32 v143, v143
  v_mfma_f32_16x16x32_bf16 v[156:159], a[188:191], a[92:95], v[156:159]
  s_waitcnt lgkmcnt(2)
  v_cvt_pk_bf16_f32 v136, v136, v137
  v_cvt_pk_bf16_f32 v137, v138, v139
  v_mfma_f32_16x16x32_bf16 v[0:3], a[192:195], v[128:131], v[0:3]
  v_exp_f32 v144, v144
  v_mfma_f32_16x16x32_bf16 v[4:7], a[196:199], v[128:131], v[4:7]
  v_cvt_pk_bf16_f32 v138, v140, v141
  v_cvt_pk_bf16_f32 v139, v142, v143
  v_mfma_f32_16x16x32_bf16 v[8:11], a[200:203], v[128:131], v[8:11]
  v_exp_f32 v145, v145
  v_mfma_f32_16x16x32_bf16 v[12:15], a[204:207], v[128:131], v[12:15]
  ds_read_b128 a[160:163], v209
  ds_read_b128 a[164:167], v209 offset:256
  v_mfma_f32_16x16x32_bf16 v[16:19], a[208:211], v[128:131], v[16:19]
  v_exp_f32 v146, v146
  v_mfma_f32_16x16x32_bf16 v[20:23], a[212:215], v[128:131], v[20:23]
  ds_read_b128 a[168:171], v209 offset:512
  ds_read_b128 a[172:175], v209 offset:768
  v_mfma_f32_16x16x32_bf16 v[24:27], a[216:219], v[128:131], v[24:27]
  s_waitcnt lgkmcnt(4)
  v_exp_f32 v147, v147
  v_mfma_f32_16x16x32_bf16 v[28:31], a[220:223], v[128:131], v[28:31]
  ds_read_b128 a[176:179], v209 offset:4096
  ds_read_b128 a[180:183], v209 offset:4352
  v_mfma_f32_16x16x32_bf16 v[184:187], a[224:227], v[128:131], v[184:187]
  v_exp_f32 v148, v148
  v_mfma_f32_16x16x32_bf16 v[32:35], a[192:195], v[136:139], v[32:35]
  ds_read_b128 a[184:187], v209 offset:4608
  ds_read_b128 a[188:191], v209 offset:4864
  v_mfma_f32_16x16x32_bf16 v[36:39], a[196:199], v[136:139], v[36:39]
  v_exp_f32 v149, v149
  v_mfma_f32_16x16x32_bf16 v[40:43], a[200:203], v[136:139], v[40:43]
  ds_read_b64_tr_b16 a[192:193], v211 offset:57344
  ds_read_b64_tr_b16 a[194:195], v211 offset:61440
  v_mfma_f32_16x16x32_bf16 v[44:47], a[204:207], v[136:139], v[44:47]
  v_exp_f32 v150, v150
  v_mfma_f32_16x16x32_bf16 v[48:51], a[208:211], v[136:139], v[48:51]
  ds_read_b64_tr_b16 a[196:197], v214 offset:57344
  ds_read_b64_tr_b16 a[198:199], v214 offset:61440
  v_mfma_f32_16x16x32_bf16 v[52:55], a[212:215], v[136:139], v[52:55]
  v_exp_f32 v151, v151
  v_mfma_f32_16x16x32_bf16 v[56:59], a[216:219], v[136:139], v[56:59]
  ds_read_b64_tr_b16 a[200:201], v211 offset:57600
  ds_read_b64_tr_b16 a[202:203], v211 offset:61696
  v_mfma_f32_16x16x32_bf16 v[60:63], a[220:223], v[136:139], v[60:63]
  ds_read_b64_tr_b16 a[204:205], v214 offset:57600
  ds_read_b64_tr_b16 a[206:207], v214 offset:61696
  v_mfma_f32_16x16x32_bf16 v[188:191], a[224:227], v[136:139], v[188:191]
  s_waitcnt lgkmcnt(10)
  v_mfma_f32_16x16x32_bf16 v[128:131], a[160:163], a[64:67], v[160:163]
  v_exp_f32 v152, v152
  v_mfma_f32_16x16x32_bf16 v[128:131], a[164:167], a[68:71], v[128:131]
  ds_read_b64_tr_b16 a[208:209], v211 offset:57856
  ds_read_b64_tr_b16 a[210:211], v211 offset:61952
  v_mfma_f32_16x16x32_bf16 v[128:131], a[168:171], a[72:75], v[128:131]
  v_exp_f32 v153, v153
  v_mfma_f32_16x16x32_bf16 v[128:131], a[172:175], a[76:79], v[128:131]
  ds_read_b64_tr_b16 a[212:213], v214 offset:57856
  ds_read_b64_tr_b16 a[214:215], v214 offset:61952
  v_mfma_f32_16x16x32_bf16 v[132:135], a[176:179], a[64:67], v[160:163]
  v_exp_f32 v154, v154
  v_mfma_f32_16x16x32_bf16 v[132:135], a[180:183], a[68:71], v[132:135]
  s_waitcnt lgkmcnt(8)
  ds_read_b64_tr_b16 a[216:217], v211 offset:58112
  ds_read_b64_tr_b16 a[218:219], v211 offset:62208
  v_mfma_f32_16x16x32_bf16 v[132:135], a[184:187], a[72:75], v[132:135]
  v_exp_f32 v155, v155
  v_mfma_f32_16x16x32_bf16 v[132:135], a[188:191], a[76:79], v[132:135]
  s_waitcnt vmcnt(0)
  s_barrier
  v_mfma_f32_16x16x32_bf16 v[136:139], a[160:163], a[80:83], v[164:167]
  v_exp_f32 v156, v156
  v_mfma_f32_16x16x32_bf16 v[136:139], a[164:167], a[84:87], v[136:139]
  ds_read_b64_tr_b16 a[220:221], v214 offset:58112
  ds_read_b64_tr_b16 a[222:223], v214 offset:62208
  v_mfma_f32_16x16x32_bf16 v[136:139], a[168:171], a[88:91], v[136:139]
  v_exp_f32 v157, v157
  v_mfma_f32_16x16x32_bf16 v[136:139], a[172:175], a[92:95], v[136:139]
  v_cvt_pk_bf16_f32 v144, v144, v145
  v_cvt_pk_bf16_f32 v145, v146, v147
TP18:
  s_cbranch_execz L_TRET
  v_mfma_f32_16x16x32_bf16 v[140:143], a[176:179], a[80:83], v[164:167]
  v_exp_f32 v158, v158
  v_mfma_f32_16x16x32_bf16 v[140:143], a[180:183], a[84:87], v[140:143]
  v_cvt_pk_bf16_f32 v146, v148, v149
  v_cvt_pk_bf16_f32 v147, v150, v151
  v_mfma_f32_16x16x32_bf16 v[140:143], a[184:187], a[88:91], v[140:143]
  v_exp_f32 v159, v159
  v_mfma_f32_16x16x32_bf16 v[140:143], a[188:191], a[92:95], v[140:143]
  v_cvt_pk_bf16_f32 v152, v152, v153
  v_cvt_pk_bf16_f32 v153, v154, v155
  v_mfma_f32_16x16x32_bf16 v[0:3], a[192:195], v[144:147], v[0:3]
  v_exp_f32 v128, v128
  v_mfma_f32_16x16x32_bf16 v[4:7], a[196:199], v[144:147], v[4:7]
  s_waitcnt lgkmcnt(2)
  v_cvt_pk_bf16_f32 v154, v156, v157
  v_cvt_pk_bf16_f32 v155, v158, v159
  v_mfma_f32_16x16x32_bf16 v[8:11], a[200:203], v[144:147], v[8:11]
  v_exp_f32 v129, v129
  v_mfma_f32_16x16x32_bf16 v[12:15], a[204:207], v[144:147], v[12:15]
  ds_read_b128 a[160:163], v209 offset:16384
  ds_read_b128 a[164:167], v209 offset:16640
  v_mfma_f32_16x16x32_bf16 v[16:19], a[208:211], v[144:147], v[16:19]
  v_exp_f32 v130, v130
  v_mfma_f32_16x16x32_bf16 v[20:23], a[212:215], v[144:147], v[20:23]
  ds_read_b128 a[168:171], v209 offset:16896
  ds_read_b128 a[172:175], v209 offset:17152
  v_mfma_f32_16x16x32_bf16 v[24:27], a[216:219], v[144:147], v[24:27]
  s_waitcnt lgkmcnt(4)
  v_exp_f32 v131, v131
  v_mfma_f32_16x16x32_bf16 v[28:31], a[220:223], v[144:147], v[28:31]
  ds_read_b128 a[176:179], v209 offset:20480
  ds_read_b128 a[180:183], v209 offset:20736
  v_mfma_f32_16x16x32_bf16 v[184:187], a[224:227], v[144:147], v[184:187]
  v_exp_f32 v132, v132
  v_mfma_f32_16x16x32_bf16 v[32:35], a[192:195], v[152:155], v[32:35]
  ds_read_b128 a[184:187], v209 offset:20992
  ds_read_b128 a[188:191], v209 offset:21248
  v_mfma_f32_16x16x32_bf16 v[36:39], a[196:199], v[152:155], v[36:39]
  v_exp_f32 v133, v133
  v_mfma_f32_16x16x32_bf16 v[40:43], a[200:203], v[152:155], v[40:43]
  ds_read_b64_tr_b16 a[192:193], v212 offset:8192
  ds_read_b64_tr_b16 a[194:195], v212 offset:12288
  v_mfma_f32_16x16x32_bf16 v[44:47], a[204:207], v[152:155], v[44:47]
  v_exp_f32 v134, v134
  v_mfma_f32_16x16x32_bf16 v[48:51], a[208:211], v[152:155], v[48:51]
  ds_read_b64_tr_b16 a[196:197], v215 offset:8192
  ds_read_b64_tr_b16 a[198:199], v215 offset:12288
  v_mfma_f32_16x16x32_bf16 v[52:55], a[212:215], v[152:155], v[52:55]
  v_exp_f32 v135, v135
  v_mfma_f32_16x16x32_bf16 v[56:59], a[216:219], v[152:155], v[56:59]
  ds_read_b64_tr_b16 a[200:201], v212 offset:8448
  ds_read_b64_tr_b16 a[202:203], v212 offset:12544
  v_mfma_f32_16x16x32_bf16 v[60:63], a[220:223], v[152:155], v[60:63]
  ds_read_b64_tr_b16 a[204:205], v215 offset:8448
  ds_read_b64_tr_b16 a[206:207], v215 offset:12544
  v_mfma_f32_16x16x32_bf16 v[188:191], a[224:227], v[152:155], v[188:191]
  s_waitcnt lgkmcnt(10)
  v_mfma_f32_16x16x32_bf16 v[144:147], a[160:163], a[64:67], v[160:163]
  v_exp_f32 v136, v136
  v_mfma_f32_16x16x32_bf16 v[144:147], a[164:167], a[68:71], v[144:147]
  ds_read_b64_tr_b16 a[208:209], v212 offset:8704
  ds_read_b64_tr_b16 a[210:211], v212 offset:12800
  v_mfma_f32_16x16x32_bf16 v[144:147], a[168:171], a[72:75], v[144:147]
  v_exp_f32 v137, v137
  v_mfma_f32_16x16x32_bf16 v[144:147], a[172:175], a[76:79], v[144:147]
  ds_read_b64_tr_b16 a[212:213], v215 offset:8704
  ds_read_b64_tr_b16 a[214:215], v215 offset:12800
  v_mfma_f32_16x16x32_bf16 v[148:151], a[176:179], a[64:67], v[160:163]
  v_exp_f32 v138, v138
  v_mfma_f32_16x16x32_bf16 v[148:151], a[180:183], a[68:71], v[148:151]
  s_waitcnt lgkmcnt(8)
  ds_read_b64_tr_b16 a[216:217], v212 offset:8960
  ds_read_b64_tr_b16 a[218:219], v212 offset:13056
  v_mfma_f32_16x16x32_bf16 v[148:151], a[184:187], a[72:75], v[148:151]
  v_exp_f32 v139, v139
  v_mfma_f32_16x16x32_bf16 v[148:151], a[188:191], a[76:79], v[148:151]
  ds_read_b64_tr_b16 a[220:221], v215 offset:8960
  ds_read_b64_tr_b16 a[222:223], v215 offset:13056
  v_mfma_f32_16x16x32_bf16 v[152:155], a[160:163], a[80:83], v[164:167]
  v_exp_f32 v140, v140
  v_mfma_f32_16x16x32_bf16 v[152:155], a[164:167], a[84:87], v[152:155]
  v_cvt_pk_bf16_f32 v128, v128, v129
  v_cvt_pk_bf16_f32 v129, v130, v131
  v_mfma_f32_16x16x32_bf16 v[152:155], a[168:171], a[88:91], v[152:155]
  v_exp_f32 v141, v141
  v_mfma_f32_16x16x32_bf16 v[152:155], a[172:175], a[92:95], v[152:155]
  v_cvt_pk_bf16_f32 v130, v132, v133
  v_cvt_pk_bf16_f32 v131, v134, v135
  v_mfma_f32_16x16x32_bf16 v[156:159], a[176:179], a[80:83], v[164:167]
  v_exp_f32 v142, v142
  v_mfma_f32_16x16x32_bf16 v[156:159], a[180:183], a[84:87], v[156:159]
  v_cvt_pk_bf16_f32 v136, v136, v137
  v_cvt_pk_bf16_f32 v137, v138, v139
  v_mfma_f32_16x16x32_bf16 v[156:159], a[184:187], a[88:91], v[156:159]
  v_exp_f32 v143, v143
  v_mfma_f32_16x16x32_bf16 v[156:159], a[188:191], a[92:95], v[156:159]
  v_cvt_pk_bf16_f32 v138, v140, v141
  v_cvt_pk_bf16_f32 v139, v142, v143
  v_mfma_f32_16x16x32_bf16 v[0:3], a[192:195], v[128:131], v[0:3]
  v_exp_f32 v144, v144
  v_mfma_f32_16x16x32_bf16 v[4:7], a[196:199], v[128:131], v[4:7]
  s_waitcnt lgkmcnt(0)
  ds_read_b128 a[160:163], v208 offset:32768
  ds_read_b128 a[164:167], v208 offset:33024
  v_mfma_f32_16x16x32_bf16 v[8:11], a[200:203], v[128:131], v[8:11]
  v_exp_f32 v145, v145
  v_mfma_f32_16x16x32_bf16 v[12:15], a[204:207], v[128:131], v[12:15]
  ds_read_b128 a[168:171], v208 offset:33280
  ds_read_b128 a[172:175], v208 offset:33536
  v_mfma_f32_16x16x32_bf16 v[16:19], a[208:211], v[128:131], v[16:19]
  v_exp_f32 v146, v146
  v_mfma_f32_16x16x32_bf16 v[20:23], a[212:215], v[128:131], v[20:23]
  ds_read_b128 a[176:179], v208 offset:36864
  ds_read_b128 a[180:183], v208 offset:37120
  v_mfma_f32_16x16x32_bf16 v[24:27], a[216:219], v[128:131], v[24:27]
  v_exp_f32 v147, v147
  v_mfma_f32_16x16x32_bf16 v[28:31], a[220:223], v[128:131], v[28:31]
  ds_read_b128 a[184:187], v208 offset:37376
  ds_read_b128 a[188:191], v208 offset:37632
  v_mfma_f32_16x16x32_bf16 v[184:187], a[224:227], v[128:131], v[184:187]
  v_exp_f32 v148, v148
  v_mfma_f32_16x16x32_bf16 v[32:35], a[192:195], v[136:139], v[32:35]
  v_mfma_f32_16x16x32_bf16 v[36:39], a[196:199], v[136:139], v[36:39]
  v_exp_f32 v149, v149
  v_mfma_f32_16x16x32_bf16 v[40:43], a[200:203], v[136:139], v[40:43]
  ds_read_b64_tr_b16 a[192:193], v212 offset:24576
  ds_read_b64_tr_b16 a[194:195], v212 offset:28672
  v_mfma_f32_16x16x32_bf16 v[44:47], a[204:207], v[136:139], v[44:47]
  v_exp_f32 v150, v150
  v_mfma_f32_16x16x32_bf16 v[48:51], a[208:211], v[136:139], v[48:51]
  ds_read_b64_tr_b16 a[196:197], v215 offset:24576
  ds_read_b64_tr_b16 a[198:199], v215 offset:28672
  v_mfma_f32_16x16x32_bf16 v[52:55], a[212:215], v[136:139], v[52:55]
  v_exp_f32 v151, v151
  v_mfma_f32_16x16x32_bf16 v[56:59], a[216:219], v[136:139], v[56:59]
  ds_read_b64_tr_b16 a[200:201], v212 offset:24832
  ds_read_b64_tr_b16 a[202:203], v212 offset:28928
  v_mfma_f32_16x16x32_bf16 v[60:63], a[220:223], v[136:139], v[60:63]
  ds_read_b64_tr_b16 a[204:205], v215 offset:24832
  ds_read_b64_tr_b16 a[206:207], v215 offset:28928
  v_mfma_f32_16x16x32_bf16 v[188:191], a[224:227], v[136:139], v[188:191]
  s_waitcnt lgkmcnt(8)
  v_mfma_f32_16x16x32_bf16 v[128:131], a[160:163], a[96:99], v[168:171]
  v_exp_f32 v152, v152
TP19:
  s_cbranch_execz L_TRET
  v_mfma_f32_16x16x32_bf16 v[128:131], a[164:167], a[100:103], v[128:131]
  ds_read_b64_tr_b16 a[208:209], v212 offset:25088
  ds_read_b64_tr_b16 a[210:211], v212 offset:29184
  v_mfma_f32_16x16x32_bf16 v[128:131], a[168:171], a[104:107], v[128:131]
  v_exp_f32 v153, v153
  v_mfma_f32_16x16x32_bf16 v[128:131], a[172:175], a[108:111], v[128:131]
  ds_read_b64_tr_b16 a[212:213], v215 offset:25088
  ds_read_b64_tr_b16 a[214:215], v215 offset:29184
  v_mfma_f32_16x16x32_bf16 v[132:135], a[176:179], a[96:99], v[168:171]
  v_exp_f32 v154, v154
  v_mfma_f32_16x16x32_bf16 v[132:135], a[180:183], a[100:103], v[132:135]
  ds_read_b64_tr_b16 a[216:217], v212 offset:25344
  ds_read_b64_tr_b16 a[218:219], v212 offset:29440
  v_mfma_f32_16x16x32_bf16 v[132:135], a[184:187], a[104:107], v[132:135]
  v_exp_f32 v155, v155
  v_mfma_f32_16x16x32_bf16 v[132:135], a[188:191], a[108:111], v[132:135]
  ds_read_b64_tr_b16 a[220:221], v215 offset:25344
  ds_read_b64_tr_b16 a[222:223], v215 offset:29440
  v_mfma_f32_16x16x32_bf16 v[136:139], a[160:163], a[112:115], v[172:175]
  v_exp_f32 v156, v156
  v_mfma_f32_16x16x32_bf16 v[136:139], a[164:167], a[116:119], v[136:139]
  v_cvt_pk_bf16_f32 v144, v144, v145
  v_cvt_pk_bf16_f32 v145, v146, v147
  v_mfma_f32_16x16x32_bf16 v[136:139], a[168:171], a[120:123], v[136:139]
  v_exp_f32 v157, v157
  v_mfma_f32_16x16x32_bf16 v[136:139], a[172:175], a[124:127], v[136:139]
  v_cvt_pk_bf16_f32 v146, v148, v149
  v_cvt_pk_bf16_f32 v147, v150, v151
  v_mfma_f32_16x16x32_bf16 v[140:143], a[176:179], a[112:115], v[172:175]
  v_exp_f32 v158, v158
  v_mfma_f32_16x16x32_bf16 v[140:143], a[180:183], a[116:119], v[140:143]
  v_cvt_pk_bf16_f32 v152, v152, v153
  v_cvt_pk_bf16_f32 v153, v154, v155
  v_mfma_f32_16x16x32_bf16 v[140:143], a[184:187], a[120:123], v[140:143]
  v_exp_f32 v159, v159
  v_mfma_f32_16x16x32_bf16 v[140:143], a[188:191], a[124:127], v[140:143]
  s_waitcnt lgkmcnt(2)
  v_cvt_pk_bf16_f32 v154, v156, v157
  v_cvt_pk_bf16_f32 v155, v158, v159
  v_mfma_f32_16x16x32_bf16 v[0:3], a[192:195], v[144:147], v[0:3]
  v_exp_f32 v128, v128
  v_mfma_f32_16x16x32_bf16 v[4:7], a[196:199], v[144:147], v[4:7]
  ds_read_b128 a[160:163], v208 offset:49152
  ds_read_b128 a[164:167], v208 offset:49408
  v_mfma_f32_16x16x32_bf16 v[8:11], a[200:203], v[144:147], v[8:11]
  v_exp_f32 v129, v129
  v_mfma_f32_16x16x32_bf16 v[12:15], a[204:207], v[144:147], v[12:15]
  ds_read_b128 a[168:171], v208 offset:49664
  ds_read_b128 a[172:175], v208 offset:49920
  v_mfma_f32_16x16x32_bf16 v[16:19], a[208:211], v[144:147], v[16:19]
  v_exp_f32 v130, v130
  v_mfma_f32_16x16x32_bf16 v[20:23], a[212:215], v[144:147], v[20:23]
  ds_read_b128 a[176:179], v208 offset:53248
  ds_read_b128 a[180:183], v208 offset:53504
  v_mfma_f32_16x16x32_bf16 v[24:27], a[216:219], v[144:147], v[24:27]
  s_waitcnt lgkmcnt(6)
  v_exp_f32 v131, v131
  v_mfma_f32_16x16x32_bf16 v[28:31], a[220:223], v[144:147], v[28:31]
  ds_read_b128 a[184:187], v208 offset:53760
  ds_read_b128 a[188:191], v208 offset:54016
  v_mfma_f32_16x16x32_bf16 v[184:187], a[224:227], v[144:147], v[184:187]
  v_exp_f32 v132, v132
  v_mfma_f32_16x16x32_bf16 v[32:35], a[192:195], v[152:155], v[32:35]
  v_mfma_f32_16x16x32_bf16 v[36:39], a[196:199], v[152:155], v[36:39]
  v_exp_f32 v133, v133
  v_mfma_f32_16x16x32_bf16 v[40:43], a[200:203], v[152:155], v[40:43]
  ds_read_b64_tr_b16 a[192:193], v211 offset:40960
  ds_read_b64_tr_b16 a[194:195], v211 offset:45056
  s_nop 0
  v_cmp_gt_f32 vcc, s37, v184
  v_mfma_f32_16x16x32_bf16 v[44:47], a[204:207], v[152:155], v[44:47]
  v_exp_f32 v134, v134
  v_rcp_f32 v237, v184
  v_mfma_f32_16x16x32_bf16 v[48:51], a[208:211], v[152:155], v[48:51]
  ds_read_b64_tr_b16 a[196:197], v214 offset:40960
  ds_read_b64_tr_b16 a[198:199], v214 offset:45056
  v_cndmask_b32 v232, v236, v232, vcc
  v_mfma_f32_16x16x32_bf16 v[52:55], a[212:215], v[152:155], v[52:55]
  v_exp_f32 v135, v135
  v_mfma_f32_16x16x32_bf16 v[56:59], a[216:219], v[152:155], v[56:59]
  ds_read_b64_tr_b16 a[200:201], v211 offset:41216
  ds_read_b64_tr_b16 a[202:203], v211 offset:45312
  v_mfma_f32_16x16x32_bf16 v[60:63], a[220:223], v[152:155], v[60:63]
  ds_read_b64_tr_b16 a[204:205], v214 offset:41216
  ds_read_b64_tr_b16 a[206:207], v214 offset:45312
  v_mfma_f32_16x16x32_bf16 v[188:191], a[224:227], v[152:155], v[188:191]
  s_waitcnt lgkmcnt(8)
  v_pk_mul_f32 v[0:1], v[0:1], v[236:237] op_sel:[0,1] op_sel_hi:[1,1]
  v_pk_mul_f32 v[2:3], v[2:3], v[236:237] op_sel:[0,1] op_sel_hi:[1,1]
  v_pk_mul_f32 v[4:5], v[4:5], v[236:237] op_sel:[0,1] op_sel_hi:[1,1]
  v_pk_mul_f32 v[6:7], v[6:7], v[236:237] op_sel:[0,1] op_sel_hi:[1,1]
  v_pk_mul_f32 v[8:9], v[8:9], v[236:237] op_sel:[0,1] op_sel_hi:[1,1]
  v_pk_mul_f32 v[10:11], v[10:11], v[236:237] op_sel:[0,1] op_sel_hi:[1,1]
  v_pk_mul_f32 v[12:13], v[12:13], v[236:237] op_sel:[0,1] op_sel_hi:[1,1]
  v_pk_mul_f32 v[14:15], v[14:15], v[236:237] op_sel:[0,1] op_sel_hi:[1,1]
  v_pk_mul_f32 v[16:17], v[16:17], v[236:237] op_sel:[0,1] op_sel_hi:[1,1]
  v_pk_mul_f32 v[18:19], v[18:19], v[236:237] op_sel:[0,1] op_sel_hi:[1,1]
  v_pk_mul_f32 v[20:21], v[20:21], v[236:237] op_sel:[0,1] op_sel_hi:[1,1]
  v_pk_mul_f32 v[22:23], v[22:23], v[236:237] op_sel:[0,1] op_sel_hi:[1,1]
  v_pk_mul_f32 v[24:25], v[24:25], v[236:237] op_sel:[0,1] op_sel_hi:[1,1]
  v_pk_mul_f32 v[26:27], v[26:27], v[236:237] op_sel:[0,1] op_sel_hi:[1,1]
  v_pk_mul_f32 v[28:29], v[28:29], v[236:237] op_sel:[0,1] op_sel_hi:[1,1]
  v_pk_mul_f32 v[30:31], v[30:31], v[236:237] op_sel:[0,1] op_sel_hi:[1,1]
  v_mfma_f32_16x16x32_bf16 v[144:147], a[160:163], a[96:99], v[168:171]
  v_exp_f32 v136, v136
  v_cvt_pk_bf16_f32 v0, v0, v1
  v_cvt_pk_bf16_f32 v1, v2, v3
  v_mfma_f32_16x16x32_bf16 v[144:147], a[164:167], a[100:103], v[144:147]
  ds_read_b64_tr_b16 a[208:209], v211 offset:41472
  ds_read_b64_tr_b16 a[210:211], v211 offset:45568
  ds_write_b64 v226, v[0:1]
  v_cvt_pk_bf16_f32 v4, v4, v5
  v_mfma_f32_16x16x32_bf16 v[144:147], a[168:171], a[104:107], v[144:147]
  v_exp_f32 v137, v137
  v_cvt_pk_bf16_f32 v5, v6, v7
  v_mfma_f32_16x16x32_bf16 v[144:147], a[172:175], a[108:111], v[144:147]
  ds_read_b64_tr_b16 a[212:213], v214 offset:41472
  ds_read_b64_tr_b16 a[214:215], v214 offset:45568
  ds_write_b64 v227, v[4:5]
  v_cvt_pk_bf16_f32 v8, v8, v9
  v_mfma_f32_16x16x32_bf16 v[148:151], a[176:179], a[96:99], v[168:171]
  v_exp_f32 v138, v138
  v_cvt_pk_bf16_f32 v9, v10, v11
  v_mfma_f32_16x16x32_bf16 v[148:151], a[180:183], a[100:103], v[148:151]
  ds_read_b64_tr_b16 a[216:217], v211 offset:41728
  ds_read_b64_tr_b16 a[218:219], v211 offset:45824
  ds_write_b64 v228, v[8:9]
  v_cvt_pk_bf16_f32 v12, v12, v13
  v_mfma_f32_16x16x32_bf16 v[148:151], a[184:187], a[104:107], v[148:151]
  v_exp_f32 v139, v139
  v_cvt_pk_bf16_f32 v13, v14, v15
  v_mfma_f32_16x16x32_bf16 v[148:151], a[188:191], a[108:111], v[148:151]
  ds_read_b64_tr_b16 a[220:221], v214 offset:41728
  ds_read_b64_tr_b16 a[222:223], v214 offset:45824
  ds_write_b64 v229, v[12:13]
  v_cvt_pk_bf16_f32 v16, v16, v17
  v_mfma_f32_16x16x32_bf16 v[152:155], a[160:163], a[112:115], v[172:175]
  v_exp_f32 v140, v140
  v_cvt_pk_bf16_f32 v17, v18, v19
  v_mfma_f32_16x16x32_bf16 v[152:155], a[164:167], a[116:119], v[152:155]
  ds_write_b64 v226, v[16:17] offset:128
  v_cvt_pk_bf16_f32 v128, v128, v129
  v_cvt_pk_bf16_f32 v129, v130, v131
TP20:
  s_cbranch_execz L_TRET
  v_mfma_f32_16x16x32_bf16 v[152:155], a[168:171], a[120:123], v[152:155]
  v_exp_f32 v141, v141
  v_cvt_pk_bf16_f32 v20, v20, v21
  v_cvt_pk_bf16_f32 v21, v22, v23
  v_mfma_f32_16x16x32_bf16 v[152:155], a[172:175], a[124:127], v[152:155]
  ds_write_b64 v227, v[20:21] offset:128
  v_cvt_pk_bf16_f32 v130, v132, v133
  v_cvt_pk_bf16_f32 v131, v134, v135
  v_mfma_f32_16x16x32_bf16 v[156:159], a[176:179], a[112:115], v[172:175]
  v_exp_f32 v142, v142
  v_cvt_pk_bf16_f32 v24, v24, v25
  v_cvt_pk_bf16_f32 v25, v26, v27
  v_mfma_f32_16x16x32_bf16 v[156:159], a[180:183], a[116:119], v[156:159]
  ds_write_b64 v228, v[24:25] offset:128
  v_cvt_pk_bf16_f32 v136, v136, v137
  v_cvt_pk_bf16_f32 v137, v138, v139
  v_mfma_f32_16x16x32_bf16 v[156:159], a[184:187], a[120:123], v[156:159]
  v_exp_f32 v143, v143
  v_cvt_pk_bf16_f32 v28, v28, v29
  v_cvt_pk_bf16_f32 v29, v30, v31
  v_mfma_f32_16x16x32_bf16 v[156:159], a[188:191], a[124:127], v[156:159]
  s_waitcnt lgkmcnt(6)
  ds_write_b64 v229, v[28:29] offset:128
  v_cvt_pk_bf16_f32 v138, v140, v141
  v_cvt_pk_bf16_f32 v139, v142, v143
  v_mfma_f32_16x16x32_bf16 v[64:67], a[192:195], v[128:131], v[64:67]
  ds_read_b128 v[0:3], v233
  ds_read_b128 v[4:7], v234 offset:1024
  v_exp_f32 v144, v144
  v_mfma_f32_16x16x32_bf16 v[68:71], a[196:199], v[128:131], v[68:71]
  ds_read_b128 a[160:163], v209
  ds_read_b128 a[164:167], v209 offset:256
  ds_read_b128 v[8:11], v233 offset:2048
  ds_read_b128 v[12:15], v234 offset:3072
  v_mfma_f32_16x16x32_bf16 v[72:75], a[200:203], v[128:131], v[72:75]
  v_exp_f32 v145, v145
  v_cmp_gt_f32 vcc, s37, v188
  v_mfma_f32_16x16x32_bf16 v[76:79], a[204:207], v[128:131], v[76:79]
  ds_read_b128 a[168:171], v209 offset:512
  ds_read_b128 a[172:175], v209 offset:768
  v_rcp_f32 v238, v188
  v_mfma_f32_16x16x32_bf16 v[80:83], a[208:211], v[128:131], v[80:83]
  v_exp_f32 v146, v146
  v_cndmask_b32 v232, v236, v232, vcc
  v_mfma_f32_16x16x32_bf16 v[84:87], a[212:215], v[128:131], v[84:87]
  ds_read_b128 a[176:179], v209 offset:4096
  ds_read_b128 a[180:183], v209 offset:4352
  s_waitcnt lgkmcnt(9)
  buffer_store_dwordx4 v[0:3], v235, s[24:27], s43 offen sc0 sc1 nt
  v_mfma_f32_16x16x32_bf16 v[88:91], a[216:219], v[128:131], v[88:91]
  v_exp_f32 v147, v147
  v_pk_mul_f32 v[32:33], v[32:33], v[238:239] op_sel:[0,0] op_sel_hi:[1,0]
  v_pk_mul_f32 v[34:35], v[34:35], v[238:239] op_sel:[0,0] op_sel_hi:[1,0]
  v_pk_mul_f32 v[36:37], v[36:37], v[238:239] op_sel:[0,0] op_sel_hi:[1,0]
  v_pk_mul_f32 v[38:39], v[38:39], v[238:239] op_sel:[0,0] op_sel_hi:[1,0]
  v_pk_mul_f32 v[40:41], v[40:41], v[238:239] op_sel:[0,0] op_sel_hi:[1,0]
  v_pk_mul_f32 v[42:43], v[42:43], v[238:239] op_sel:[0,0] op_sel_hi:[1,0]
  v_pk_mul_f32 v[44:45], v[44:45], v[238:239] op_sel:[0,0] op_sel_hi:[1,0]
  v_pk_mul_f32 v[46:47], v[46:47], v[238:239] op_sel:[0,0] op_sel_hi:[1,0]
  v_pk_mul_f32 v[48:49], v[48:49], v[238:239] op_sel:[0,0] op_sel_hi:[1,0]
  v_pk_mul_f32 v[50:51], v[50:51], v[238:239] op_sel:[0,0] op_sel_hi:[1,0]
  v_pk_mul_f32 v[52:53], v[52:53], v[238:239] op_sel:[0,0] op_sel_hi:[1,0]
  v_pk_mul_f32 v[54:55], v[54:55], v[238:239] op_sel:[0,0] op_sel_hi:[1,0]
  v_pk_mul_f32 v[56:57], v[56:57], v[238:239] op_sel:[0,0] op_sel_hi:[1,0]
  v_pk_mul_f32 v[58:59], v[58:59], v[238:239] op_sel:[0,0] op_sel_hi:[1,0]
  v_pk_mul_f32 v[60:61], v[60:61], v[238:239] op_sel:[0,0] op_sel_hi:[1,0]
  v_pk_mul_f32 v[62:63], v[62:63], v[238:239] op_sel:[0,0] op_sel_hi:[1,0]
  v_mfma_f32_16x16x32_bf16 v[92:95], a[220:223], v[128:131], v[92:95]
  ds_read_b128 a[184:187], v209 offset:4608
  ds_read_b128 a[188:191], v209 offset:4864
  v_cvt_pk_bf16_f32 v32, v32, v33
  v_cvt_pk_bf16_f32 v33, v34, v35
  v_mfma_f32_16x16x32_bf16 v[192:195], a[224:227], v[128:131], v[192:195]
  ds_write_b64 v226, v[32:33] offset:4096
  v_exp_f32 v148, v148
  v_mfma_f32_16x16x32_bf16 v[96:99], a[192:195], v[136:139], v[96:99]
  v_cvt_pk_bf16_f32 v36, v36, v37
  v_cvt_pk_bf16_f32 v37, v38, v39
  v_mfma_f32_16x16x32_bf16 v[100:103], a[196:199], v[136:139], v[100:103]
  ds_write_b64 v227, v[36:37] offset:4096
  v_exp_f32 v149, v149
  v_mfma_f32_16x16x32_bf16 v[104:107], a[200:203], v[136:139], v[104:107]
  ds_read_b64_tr_b16 a[192:193], v211 offset:57344
  ds_read_b64_tr_b16 a[194:195], v211 offset:61440
  s_waitcnt lgkmcnt(10)
  buffer_store_dwordx4 v[4:7], v235, s[24:27], s43 offen offset:1024 sc0 sc1 nt
  v_cvt_pk_bf16_f32 v40, v40, v41
  v_mfma_f32_16x16x32_bf16 v[108:111], a[204:207], v[136:139], v[108:111]
  v_exp_f32 v150, v150
  v_cvt_pk_bf16_f32 v41, v42, v43
  v_mfma_f32_16x16x32_bf16 v[112:115], a[208:211], v[136:139], v[112:115]
  ds_read_b64_tr_b16 a[196:197], v214 offset:57344
  ds_read_b64_tr_b16 a[198:199], v214 offset:61440
  ds_write_b64 v228, v[40:41] offset:4096
  v_cvt_pk_bf16_f32 v44, v44, v45
  v_mfma_f32_16x16x32_bf16 v[116:119], a[212:215], v[136:139], v[116:119]
  v_exp_f32 v151, v151
  v_cvt_pk_bf16_f32 v45, v46, v47
  v_mfma_f32_16x16x32_bf16 v[120:123], a[216:219], v[136:139], v[120:123]
  ds_read_b64_tr_b16 a[200:201], v211 offset:57600
  ds_read_b64_tr_b16 a[202:203], v211 offset:61696
  ds_write_b64 v229, v[44:45] offset:4096
  v_cvt_pk_bf16_f32 v48, v48, v49
  v_mfma_f32_16x16x32_bf16 v[124:127], a[220:223], v[136:139], v[124:127]
  ds_read_b64_tr_b16 a[204:205], v214 offset:57600
  ds_read_b64_tr_b16 a[206:207], v214 offset:61696
  v_cvt_pk_bf16_f32 v49, v50, v51
  v_mfma_f32_16x16x32_bf16 v[196:199], a[224:227], v[136:139], v[196:199]
  buffer_store_dwordx4 v[8:11], v235, s[24:27], s43 offen offset:2048 sc0 sc1 nt
  v_mfma_f32_16x16x32_bf16 v[128:131], a[160:163], a[96:99], v[168:171]
  ds_write_b64 v226, v[48:49] offset:4224
  v_exp_f32 v152, v152
  v_mfma_f32_16x16x32_bf16 v[128:131], a[164:167], a[100:103], v[128:131]
  s_waitcnt lgkmcnt(12)
  ds_read_b64_tr_b16 a[208:209], v211 offset:57856
  ds_read_b64_tr_b16 a[210:211], v211 offset:61952
  v_cvt_pk_bf16_f32 v52, v52, v53
  v_cvt_pk_bf16_f32 v53, v54, v55
  v_mfma_f32_16x16x32_bf16 v[128:131], a[168:171], a[104:107], v[128:131]
  ds_write_b64 v227, v[52:53] offset:4224
  v_exp_f32 v153, v153
  v_mfma_f32_16x16x32_bf16 v[128:131], a[172:175], a[108:111], v[128:131]
  ds_read_b64_tr_b16 a[212:213], v214 offset:57856
  ds_read_b64_tr_b16 a[214:215], v214 offset:61952
  v_cvt_pk_bf16_f32 v56, v56, v57
  v_cvt_pk_bf16_f32 v57, v58, v59
  v_mfma_f32_16x16x32_bf16 v[132:135], a[176:179], a[96:99], v[168:171]
  ds_write_b64 v228, v[56:57] offset:4224
  v_exp_f32 v154, v154
  v_mfma_f32_16x16x32_bf16 v[132:135], a[180:183], a[100:103], v[132:135]
  ds_read_b64_tr_b16 a[216:217], v211 offset:58112
  ds_read_b64_tr_b16 a[218:219], v211 offset:62208
  buffer_store_dwordx4 v[12:15], v235, s[24:27], s43 offen offset:3072 sc0 sc1 nt
  v_cvt_pk_bf16_f32 v60, v60, v61
  v_mfma_f32_16x16x32_bf16 v[132:135], a[184:187], a[104:107], v[132:135]
  v_exp_f32 v155, v155
  v_cvt_pk_bf16_f32 v61, v62, v63
TP21:
  s_cbranch_execz L_TRET
  v_mfma_f32_16x16x32_bf16 v[132:135], a[188:191], a[108:111], v[132:135]
  ds_read_b64_tr_b16 a[220:221], v214 offset:58112
  ds_read_b64_tr_b16 a[222:223], v214 offset:62208
  ds_write_b64 v229, v[60:61] offset:4224
  ds_read_b128 v[16:19], v233 offset:4096
  v_mfma_f32_16x16x32_bf16 v[136:139], a[160:163], a[112:115], v[172:175]
  ds_read_b128 v[20:23], v234 offset:5120
  ds_read_b128 v[24:27], v233 offset:6144
  v_exp_f32 v156, v156
  v_mfma_f32_16x16x32_bf16 v[136:139], a[164:167], a[116:119], v[136:139]
  ds_read_b128 v[28:31], v234 offset:7168
  v_cvt_pk_bf16_f32 v144, v144, v145
  v_cvt_pk_bf16_f32 v145, v146, v147
  v_mfma_f32_16x16x32_bf16 v[136:139], a[168:171], a[120:123], v[136:139]
  v_exp_f32 v157, v157
  v_mfma_f32_16x16x32_bf16 v[136:139], a[172:175], a[124:127], v[136:139]
  v_cvt_pk_bf16_f32 v146, v148, v149
  v_cvt_pk_bf16_f32 v147, v150, v151
  v_mfma_f32_16x16x32_bf16 v[140:143], a[176:179], a[112:115], v[172:175]
  s_waitcnt lgkmcnt(3)
  buffer_store_dwordx4 v[16:19], v235, s[24:27], s64 offen sc0 sc1 nt
  v_exp_f32 v158, v158
  v_mfma_f32_16x16x32_bf16 v[140:143], a[180:183], a[116:119], v[140:143]
  v_cvt_pk_bf16_f32 v152, v152, v153
  v_cvt_pk_bf16_f32 v153, v154, v155
  v_mfma_f32_16x16x32_bf16 v[140:143], a[184:187], a[120:123], v[140:143]
  v_exp_f32 v159, v159
  v_mfma_f32_16x16x32_bf16 v[140:143], a[188:191], a[124:127], v[140:143]
  v_cvt_pk_bf16_f32 v154, v156, v157
  v_cvt_pk_bf16_f32 v155, v158, v159
  v_mfma_f32_16x16x32_bf16 v[64:67], a[192:195], v[144:147], v[64:67]
  v_exp_f32 v128, v128
  v_mfma_f32_16x16x32_bf16 v[68:71], a[196:199], v[144:147], v[68:71]
  ds_read_b128 a[160:163], v209 offset:16384
  ds_read_b128 a[164:167], v209 offset:16640
  v_mfma_f32_16x16x32_bf16 v[72:75], a[200:203], v[144:147], v[72:75]
  s_waitcnt lgkmcnt(3)
  buffer_store_dwordx4 v[20:23], v235, s[24:27], s64 offen offset:1024 sc0 sc1 nt
  v_exp_f32 v129, v129
  v_mfma_f32_16x16x32_bf16 v[76:79], a[204:207], v[144:147], v[76:79]
  ds_read_b128 a[168:171], v209 offset:16896
  ds_read_b128 a[172:175], v209 offset:17152
  v_mfma_f32_16x16x32_bf16 v[80:83], a[208:211], v[144:147], v[80:83]
  v_exp_f32 v130, v130
  v_mfma_f32_16x16x32_bf16 v[84:87], a[212:215], v[144:147], v[84:87]
  ds_read_b128 a[176:179], v209 offset:20480
  ds_read_b128 a[180:183], v209 offset:20736
  v_mfma_f32_16x16x32_bf16 v[88:91], a[216:219], v[144:147], v[88:91]
  v_exp_f32 v131, v131
  v_mfma_f32_16x16x32_bf16 v[92:95], a[220:223], v[144:147], v[92:95]
  ds_read_b128 a[184:187], v209 offset:20992
  ds_read_b128 a[188:191], v209 offset:21248
  v_mfma_f32_16x16x32_bf16 v[192:195], a[224:227], v[144:147], v[192:195]
  buffer_store_dwordx4 v[24:27], v235, s[24:27], s64 offen offset:2048 sc0 sc1 nt
  v_exp_f32 v132, v132
  v_mfma_f32_16x16x32_bf16 v[96:99], a[192:195], v[152:155], v[96:99]
  v_mfma_f32_16x16x32_bf16 v[100:103], a[196:199], v[152:155], v[100:103]
  v_exp_f32 v133, v133
  v_mfma_f32_16x16x32_bf16 v[104:107], a[200:203], v[152:155], v[104:107]
  ds_read_b64_tr_b16 a[192:193], v212 offset:8192
  ds_read_b64_tr_b16 a[194:195], v212 offset:12288
  v_mfma_f32_16x16x32_bf16 v[108:111], a[204:207], v[152:155], v[108:111]
  v_exp_f32 v134, v134
  v_mfma_f32_16x16x32_bf16 v[112:115], a[208:211], v[152:155], v[112:115]
  ds_read_b64_tr_b16 a[196:197], v215 offset:8192
  ds_read_b64_tr_b16 a[198:199], v215 offset:12288
  v_mfma_f32_16x16x32_bf16 v[116:119], a[212:215], v[152:155], v[116:119]
  s_waitcnt lgkmcnt(8)
  buffer_store_dwordx4 v[28:31], v235, s[24:27], s64 offen offset:3072 sc0 sc1 nt
  v_exp_f32 v135, v135
  v_mfma_f32_16x16x32_bf16 v[120:123], a[216:219], v[152:155], v[120:123]
  ds_read_b64_tr_b16 a[200:201], v212 offset:8448
  ds_read_b64_tr_b16 a[202:203], v212 offset:12544
  v_mfma_f32_16x16x32_bf16 v[124:127], a[220:223], v[152:155], v[124:127]
  ds_read_b64_tr_b16 a[204:205], v215 offset:8448
  ds_read_b64_tr_b16 a[206:207], v215 offset:12544
  v_mfma_f32_16x16x32_bf16 v[196:199], a[224:227], v[152:155], v[196:199]
  v_mfma_f32_16x16x32_bf16 v[144:147], a[160:163], a[96:99], v[168:171]
  v_exp_f32 v136, v136
  v_mfma_f32_16x16x32_bf16 v[144:147], a[164:167], a[100:103], v[144:147]
  ds_read_b64_tr_b16 a[208:209], v212 offset:8704
  v_add_u32 v217, s46, v208
  v_mfma_f32_16x16x32_bf16 v[144:147], a[168:171], a[104:107], v[144:147]
  v_exp_f32 v137, v137
  v_mfma_f32_16x16x32_bf16 v[144:147], a[172:175], a[108:111], v[144:147]
  s_waitcnt lgkmcnt(7)
  ds_read_b64_tr_b16 a[210:211], v212 offset:12800
  ds_read_b64_tr_b16 a[212:213], v215 offset:8704
  v_mfma_f32_16x16x32_bf16 v[148:151], a[176:179], a[96:99], v[168:171]
  v_exp_f32 v138, v138
  v_mfma_f32_16x16x32_bf16 v[148:151], a[180:183], a[100:103], v[148:151]
  ds_read_b64_tr_b16 a[214:215], v215 offset:12800
  ds_read_b64_tr_b16 a[216:217], v212 offset:8960
  v_mfma_f32_16x16x32_bf16 v[148:151], a[184:187], a[104:107], v[148:151]
  v_exp_f32 v139, v139
  v_mfma_f32_16x16x32_bf16 v[148:151], a[188:191], a[108:111], v[148:151]
  ds_read_b64_tr_b16 a[218:219], v212 offset:13056
  ds_read_b64_tr_b16 a[220:221], v215 offset:8960
  v_mfma_f32_16x16x32_bf16 v[152:155], a[160:163], a[112:115], v[172:175]
  v_exp_f32 v140, v140
  v_mfma_f32_16x16x32_bf16 v[152:155], a[164:167], a[116:119], v[152:155]
  ds_read_b64_tr_b16 a[222:223], v215 offset:13056
  v_cvt_pk_bf16_f32 v128, v128, v129
  v_mfma_f32_16x16x32_bf16 v[152:155], a[168:171], a[120:123], v[152:155]
  v_exp_f32 v141, v141
  v_mfma_f32_16x16x32_bf16 v[152:155], a[172:175], a[124:127], v[152:155]
  v_cvt_pk_bf16_f32 v129, v130, v131
  v_cvt_pk_bf16_f32 v130, v132, v133
  v_mfma_f32_16x16x32_bf16 v[156:159], a[176:179], a[112:115], v[172:175]
  v_exp_f32 v142, v142
  v_mfma_f32_16x16x32_bf16 v[156:159], a[180:183], a[116:119], v[156:159]
  v_cvt_pk_bf16_f32 v131, v134, v135
  v_cvt_pk_bf16_f32 v136, v136, v137
  v_mfma_f32_16x16x32_bf16 v[156:159], a[184:187], a[120:123], v[156:159]
  v_exp_f32 v143, v143
  v_mfma_f32_16x16x32_bf16 v[156:159], a[188:191], a[124:127], v[156:159]
  v_cvt_pk_bf16_f32 v137, v138, v139
  v_cvt_pk_bf16_f32 v138, v140, v141
  v_mfma_f32_16x16x32_bf16 v[64:67], a[192:195], v[128:131], v[64:67]
  s_waitcnt lgkmcnt(3)
  v_exp_f32 v144, v144
  v_mfma_f32_16x16x32_bf16 v[68:71], a[196:199], v[128:131], v[68:71]
  ds_read_b128 a[160:163], v217
  v_cvt_pk_bf16_f32 v139, v142, v143
  v_mfma_f32_16x16x32_bf16 v[72:75], a[200:203], v[128:131], v[72:75]
  v_exp_f32 v145, v145
  v_mfma_f32_16x16x32_bf16 v[76:79], a[204:207], v[128:131], v[76:79]
  ds_read_b128 a[164:167], v217 offset:256
  ds_read_b128 a[168:171], v217 offset:512
  v_mfma_f32_16x16x32_bf16 v[80:83], a[208:211], v[128:131], v[80:83]
  v_exp_f32 v146, v146
  v_mfma_f32_16x16x32_bf16 v[84:87], a[212:215], v[128:131], v[84:87]
  s_waitcnt lgkmcnt(3)
  ds_read_b128 a[172:175], v217 offset:768
  ds_read_b128 a[176:179], v217 offset:4096
  v_mfma_f32_16x16x32_bf16 v[88:91], a[216:219], v[128:131], v[88:91]
  v_exp_f32 v147, v147
  v_mfma_f32_16x16x32_bf16 v[92:95], a[220:223], v[128:131], v[92:95]
  ds_read_b128 a[180:183], v217 offset:4352
  ds_read_b128 a[184:187], v217 offset:4608
  v_mfma_f32_16x16x32_bf16 v[192:195], a[224:227], v[128:131], v[192:195]
  v_exp_f32 v148, v148
  v_mfma_f32_16x16x32_bf16 v[96:99], a[192:195], v[136:139], v[96:99]
  ds_read_b128 a[188:191], v217 offset:4864
TP22:
  s_cbranch_execz L_TRET
  v_mfma_f32_16x16x32_bf16 v[100:103], a[196:199], v[136:139], v[100:103]
  v_exp_f32 v149, v149
  v_mfma_f32_16x16x32_bf16 v[104:107], a[200:203], v[136:139], v[104:107]
  ds_read_b64_tr_b16 a[192:193], v212 offset:24576
  ds_read_b64_tr_b16 a[194:195], v212 offset:28672
  v_mfma_f32_16x16x32_bf16 v[108:111], a[204:207], v[136:139], v[108:111]
  v_exp_f32 v150, v150
  v_mfma_f32_16x16x32_bf16 v[112:115], a[208:211], v[136:139], v[112:115]
  ds_read_b64_tr_b16 a[196:197], v215 offset:24576
  ds_read_b64_tr_b16 a[198:199], v215 offset:28672
  v_mfma_f32_16x16x32_bf16 v[116:119], a[212:215], v[136:139], v[116:119]
  v_exp_f32 v151, v151
  v_mfma_f32_16x16x32_bf16 v[120:123], a[216:219], v[136:139], v[120:123]
  ds_read_b64_tr_b16 a[200:201], v212 offset:24832
  ds_read_b64_tr_b16 a[202:203], v212 offset:28928
  v_mfma_f32_16x16x32_bf16 v[124:127], a[220:223], v[136:139], v[124:127]
  ds_read_b64_tr_b16 a[204:205], v215 offset:24832
  ds_read_b64_tr_b16 a[206:207], v215 offset:28928
  v_mfma_f32_16x16x32_bf16 v[196:199], a[224:227], v[136:139], v[196:199]
  s_waitcnt lgkmcnt(9)
  v_mfma_f32_16x16x32_bf16 v[128:131], a[160:163], a[128:131], v[176:179]
  v_exp_f32 v152, v152
  v_add_u32 v255, s46, v253
  v_mfma_f32_16x16x32_bf16 v[128:131], a[164:167], a[132:135], v[128:131]
  ds_read_b64_tr_b16 a[208:209], v212 offset:25088
  v_add_u32 v217, s47, v208
  v_mfma_f32_16x16x32_bf16 v[128:131], a[168:171], a[136:139], v[128:131]
  v_exp_f32 v153, v153
  v_mfma_f32_16x16x32_bf16 v[128:131], a[172:175], a[140:143], v[128:131]
  ds_read_b64_tr_b16 a[210:211], v212 offset:29184
  ds_read_b64_tr_b16 a[212:213], v215 offset:25088
  v_mfma_f32_16x16x32_bf16 v[132:135], a[176:179], a[128:131], v[176:179]
  v_exp_f32 v154, v154
  v_mfma_f32_16x16x32_bf16 v[132:135], a[180:183], a[132:135], v[132:135]
  ds_read_b64_tr_b16 a[214:215], v215 offset:29184
  ds_read_b64_tr_b16 a[216:217], v212 offset:25344
  v_mfma_f32_16x16x32_bf16 v[132:135], a[184:187], a[136:139], v[132:135]
  s_waitcnt lgkmcnt(9)
  v_exp_f32 v155, v155
  v_mfma_f32_16x16x32_bf16 v[132:135], a[188:191], a[140:143], v[132:135]
  ds_read_b64_tr_b16 a[218:219], v212 offset:29440
  ds_read_b64_tr_b16 a[220:221], v215 offset:25344
  v_mfma_f32_16x16x32_bf16 v[136:139], a[160:163], a[144:147], v[180:183]
  v_exp_f32 v156, v156
  v_mfma_f32_16x16x32_bf16 v[136:139], a[164:167], a[148:151], v[136:139]
  ds_read_b64_tr_b16 a[222:223], v215 offset:29440
  v_cvt_pk_bf16_f32 v144, v144, v145
  v_mfma_f32_16x16x32_bf16 v[136:139], a[168:171], a[152:155], v[136:139]
  v_exp_f32 v157, v157
  v_exp_f32 v128, v128
  v_mfma_f32_16x16x32_bf16 v[136:139], a[172:175], a[156:159], v[136:139]
  v_cvt_pk_bf16_f32 v145, v146, v147
  v_cvt_pk_bf16_f32 v146, v148, v149
  v_exp_f32 v129, v129
  v_mfma_f32_16x16x32_bf16 v[140:143], a[176:179], a[144:147], v[180:183]
  v_exp_f32 v158, v158
  v_exp_f32 v130, v130
  v_cvt_pk_bf16_f32 v128, v128, v129
  v_mfma_f32_16x16x32_bf16 v[140:143], a[180:183], a[148:151], v[140:143]
  v_cvt_pk_bf16_f32 v147, v150, v151
  v_add_u32 v218, s61, v213
  v_exp_f32 v131, v131
  v_mfma_f32_16x16x32_bf16 v[140:143], a[184:187], a[152:155], v[140:143]
  v_exp_f32 v159, v159
  v_exp_f32 v132, v132
  v_cvt_pk_bf16_f32 v129, v130, v131
  v_mfma_f32_16x16x32_bf16 v[140:143], a[188:191], a[156:159], v[140:143]
  v_add_u32 v219, s61, v216
  v_add_u32 v230, s61, v211
  v_exp_f32 v133, v133
  v_mfma_f32_16x16x32_bf16 v[64:67], a[192:195], v[144:147], v[64:67]
  v_add_u32 v231, s61, v214
  v_cvt_pk_bf16_f32 v152, v152, v153
  v_exp_f32 v134, v134
  v_cvt_pk_bf16_f32 v130, v132, v133
  v_mfma_f32_16x16x32_bf16 v[68:71], a[196:199], v[144:147], v[68:71]
  s_waitcnt lgkmcnt(1)
  v_cvt_pk_bf16_f32 v153, v154, v155
  v_cvt_pk_bf16_f32 v154, v156, v157
  v_mfma_f32_16x16x32_bf16 v[72:75], a[200:203], v[144:147], v[72:75]
  ds_read_b128 a[160:163], v217
  v_cvt_pk_bf16_f32 v155, v158, v159
  v_mfma_f32_16x16x32_bf16 v[76:79], a[204:207], v[144:147], v[76:79]
  ds_read_b128 a[164:167], v217 offset:256
  ds_read_b128 a[168:171], v217 offset:512
  v_mfma_f32_16x16x32_bf16 v[80:83], a[208:211], v[144:147], v[80:83]
  ds_read_b128 a[172:175], v217 offset:768
  ds_read_b128 a[176:179], v217 offset:4096
  v_mfma_f32_16x16x32_bf16 v[84:87], a[212:215], v[144:147], v[84:87]
  ds_read_b128 a[180:183], v217 offset:4352
  ds_read_b128 a[184:187], v217 offset:4608
  v_mfma_f32_16x16x32_bf16 v[88:91], a[216:219], v[144:147], v[88:91]
  s_waitcnt lgkmcnt(7)
  ds_read_b128 a[188:191], v217 offset:4864
  v_exp_f32 v135, v135
  v_mfma_f32_16x16x32_bf16 v[92:95], a[220:223], v[144:147], v[92:95]
  v_exp_f32 v136, v136
  v_cvt_pk_bf16_f32 v131, v134, v135
  v_mfma_f32_16x16x32_bf16 v[192:195], a[224:227], v[144:147], v[192:195]
  ds_write_b128 v255, v[128:131]
  v_exp_f32 v137, v137
  v_mfma_f32_16x16x32_bf16 v[96:99], a[192:195], v[152:155], v[96:99]
  v_exp_f32 v138, v138
  v_cvt_pk_bf16_f32 v136, v136, v137
  v_mfma_f32_16x16x32_bf16 v[100:103], a[196:199], v[152:155], v[100:103]
  v_exp_f32 v139, v139
  v_mfma_f32_16x16x32_bf16 v[104:107], a[200:203], v[152:155], v[104:107]
  v_exp_f32 v140, v140
  v_cvt_pk_bf16_f32 v137, v138, v139
  v_cmp_gt_f32 vcc, s37, v192
  v_mfma_f32_16x16x32_bf16 v[108:111], a[204:207], v[152:155], v[108:111]
  v_exp_f32 v141, v141
  v_rcp_f32 v239, v192
  v_mfma_f32_16x16x32_bf16 v[112:115], a[208:211], v[152:155], v[112:115]
  v_exp_f32 v142, v142
  v_cndmask_b32 v232, v236, v232, vcc
  v_mfma_f32_16x16x32_bf16 v[116:119], a[212:215], v[152:155], v[116:119]
  v_exp_f32 v143, v143
  v_pk_mul_f32 v[64:65], v[64:65], v[238:239] op_sel:[0,1] op_sel_hi:[1,1]
  v_pk_mul_f32 v[66:67], v[66:67], v[238:239] op_sel:[0,1] op_sel_hi:[1,1]
  v_pk_mul_f32 v[68:69], v[68:69], v[238:239] op_sel:[0,1] op_sel_hi:[1,1]
  v_pk_mul_f32 v[70:71], v[70:71], v[238:239] op_sel:[0,1] op_sel_hi:[1,1]
  v_pk_mul_f32 v[72:73], v[72:73], v[238:239] op_sel:[0,1] op_sel_hi:[1,1]
  v_pk_mul_f32 v[74:75], v[74:75], v[238:239] op_sel:[0,1] op_sel_hi:[1,1]
  v_pk_mul_f32 v[76:77], v[76:77], v[238:239] op_sel:[0,1] op_sel_hi:[1,1]
  v_pk_mul_f32 v[78:79], v[78:79], v[238:239] op_sel:[0,1] op_sel_hi:[1,1]
  v_pk_mul_f32 v[80:81], v[80:81], v[238:239] op_sel:[0,1] op_sel_hi:[1,1]
  v_pk_mul_f32 v[82:83], v[82:83], v[238:239] op_sel:[0,1] op_sel_hi:[1,1]
  v_pk_mul_f32 v[84:85], v[84:85], v[238:239] op_sel:[0,1] op_sel_hi:[1,1]
  v_pk_mul_f32 v[86:87], v[86:87], v[238:239] op_sel:[0,1] op_sel_hi:[1,1]
  v_pk_mul_f32 v[88:89], v[88:89], v[238:239] op_sel:[0,1] op_sel_hi:[1,1]
  v_pk_mul_f32 v[90:91], v[90:91], v[238:239] op_sel:[0,1] op_sel_hi:[1,1]
  v_pk_mul_f32 v[92:93], v[92:93], v[238:239] op_sel:[0,1] op_sel_hi:[1,1]
  v_pk_mul_f32 v[94:95], v[94:95], v[238:239] op_sel:[0,1] op_sel_hi:[1,1]
  v_mfma_f32_16x16x32_bf16 v[120:123], a[216:219], v[152:155], v[120:123]
  v_cvt_pk_bf16_f32 v138, v140, v141
  v_cvt_pk_bf16_f32 v139, v142, v143
  v_cvt_pk_bf16_f32 v64, v64, v65
  v_cvt_pk_bf16_f32 v65, v66, v67
  v_mfma_f32_16x16x32_bf16 v[124:127], a[220:223], v[152:155], v[124:127]
  ds_write_b128 v255, v[136:139] offset:1024
  v_mfma_f32_16x16x32_bf16 v[196:199], a[224:227], v[152:155], v[196:199]
  s_waitcnt lgkmcnt(2)
  ds_write_b64 v226, v[64:65]
  v_cvt_pk_bf16_f32 v68, v68, v69
  v_cvt_pk_bf16_f32 v69, v70, v71
  v_mfma_f32_16x16x32_bf16 v[144:147], a[160:163], a[128:131], v[176:179]
  ds_read_b64_tr_b16 a[192:193], v218 offset:8192
  ds_write_b64 v227, v[68:69]
  v_add_u32 v255, s47, v253
  v_cvt_pk_bf16_f32 v72, v72, v73
  v_cvt_pk_bf16_f32 v73, v74, v75
TP23:
  s_cbranch_execz L_TRET
  v_mfma_f32_16x16x32_bf16 v[144:147], a[164:167], a[132:135], v[144:147]
  ds_read_b64_tr_b16 a[194:195], v218 offset:12288
  ds_read_b64_tr_b16 a[196:197], v219 offset:8192
  ds_write_b64 v228, v[72:73]
  v_add_u32 v254, 131072, v253
  v_cvt_pk_bf16_f32 v76, v76, v77
  v_cvt_pk_bf16_f32 v77, v78, v79
  v_mfma_f32_16x16x32_bf16 v[144:147], a[168:171], a[136:139], v[144:147]
  ds_read_b64_tr_b16 a[198:199], v219 offset:12288
  ds_read_b64_tr_b16 a[200:201], v218 offset:24576
  ds_write_b64 v229, v[76:77]
  v_cvt_pk_bf16_f32 v80, v80, v81
  v_cvt_pk_bf16_f32 v81, v82, v83
  v_mfma_f32_16x16x32_bf16 v[144:147], a[172:175], a[140:143], v[144:147]
  ds_read_b64_tr_b16 a[202:203], v218 offset:28672
  ds_read_b64_tr_b16 a[204:205], v219 offset:24576
  ds_write_b64 v226, v[80:81] offset:128
  v_cvt_pk_bf16_f32 v84, v84, v85
  v_cvt_pk_bf16_f32 v85, v86, v87
  v_mfma_f32_16x16x32_bf16 v[148:151], a[176:179], a[128:131], v[176:179]
  ds_read_b64_tr_b16 a[206:207], v219 offset:28672
  ds_read_b64_tr_b16 a[208:209], v230 offset:8192
  ds_write_b64 v227, v[84:85] offset:128
  v_cvt_pk_bf16_f32 v88, v88, v89
  v_cvt_pk_bf16_f32 v89, v90, v91
  v_mfma_f32_16x16x32_bf16 v[148:151], a[180:183], a[132:135], v[148:151]
  s_waitcnt lgkmcnt(15)
  s_barrier
  ds_read_b64_tr_b16 a[210:211], v230 offset:12288
  ds_write_b64 v228, v[88:89] offset:128
  v_cvt_pk_bf16_f32 v92, v92, v93
  v_cvt_pk_bf16_f32 v93, v94, v95
  v_mfma_f32_16x16x32_bf16 v[148:151], a[184:187], a[136:139], v[148:151]
  ds_read_b64_tr_b16 a[212:213], v231 offset:8192
  ds_read_b64_tr_b16 a[214:215], v231 offset:12288
  ds_write_b64 v229, v[92:93] offset:128
  ds_read_b128 v[64:67], v233
  ds_read_b128 v[68:71], v234 offset:1024
  ds_read_b128 v[72:75], v233 offset:2048
  ds_read_b128 v[76:79], v234 offset:3072
  v_cmp_gt_f32 vcc, s37, v196
  v_mfma_f32_16x16x32_bf16 v[148:151], a[188:191], a[140:143], v[148:151]
  ds_read_b64_tr_b16 a[216:217], v230 offset:24576
  ds_read_b64_tr_b16 a[218:219], v230 offset:28672
  v_rcp_f32 v240, v196
  v_mfma_f32_16x16x32_bf16 v[152:155], a[160:163], a[144:147], v[180:183]
  ds_read_b64_tr_b16 a[220:221], v231 offset:24576
  ds_read_b64_tr_b16 a[222:223], v231 offset:28672
  v_cndmask_b32 v232, v236, v232, vcc
  v_mfma_f32_16x16x32_bf16 v[152:155], a[164:167], a[148:151], v[152:155]
  ds_read_b128 a[16:19], v254
  ds_read_b128 a[24:27], v254 offset:16384
  v_pk_mul_f32 v[96:97], v[96:97], v[240:241] op_sel:[0,0] op_sel_hi:[1,0]
  v_pk_mul_f32 v[98:99], v[98:99], v[240:241] op_sel:[0,0] op_sel_hi:[1,0]
  v_pk_mul_f32 v[100:101], v[100:101], v[240:241] op_sel:[0,0] op_sel_hi:[1,0]
  v_pk_mul_f32 v[102:103], v[102:103], v[240:241] op_sel:[0,0] op_sel_hi:[1,0]
  v_pk_mul_f32 v[104:105], v[104:105], v[240:241] op_sel:[0,0] op_sel_hi:[1,0]
  v_pk_mul_f32 v[106:107], v[106:107], v[240:241] op_sel:[0,0] op_sel_hi:[1,0]
  v_pk_mul_f32 v[108:109], v[108:109], v[240:241] op_sel:[0,0] op_sel_hi:[1,0]
  v_pk_mul_f32 v[110:111], v[110:111], v[240:241] op_sel:[0,0] op_sel_hi:[1,0]
  v_pk_mul_f32 v[112:113], v[112:113], v[240:241] op_sel:[0,0] op_sel_hi:[1,0]
  v_pk_mul_f32 v[114:115], v[114:115], v[240:241] op_sel:[0,0] op_sel_hi:[1,0]
  v_pk_mul_f32 v[116:117], v[116:117], v[240:241] op_sel:[0,0] op_sel_hi:[1,0]
  v_pk_mul_f32 v[118:119], v[118:119], v[240:241] op_sel:[0,0] op_sel_hi:[1,0]
  v_pk_mul_f32 v[120:121], v[120:121], v[240:241] op_sel:[0,0] op_sel_hi:[1,0]
  v_pk_mul_f32 v[122:123], v[122:123], v[240:241] op_sel:[0,0] op_sel_hi:[1,0]
  v_pk_mul_f32 v[124:125], v[124:125], v[240:241] op_sel:[0,0] op_sel_hi:[1,0]
  v_pk_mul_f32 v[126:127], v[126:127], v[240:241] op_sel:[0,0] op_sel_hi:[1,0]
  v_mfma_f32_16x16x32_bf16 v[152:155], a[168:171], a[152:155], v[152:155]
  ds_read_b128 a[32:35], v253
  ds_read_b128 a[40:43], v253 offset:16384
  v_cvt_pk_bf16_f32 v96, v96, v97
  v_cvt_pk_bf16_f32 v97, v98, v99
  ds_write_b64 v226, v[96:97] offset:4096
  v_cvt_pk_bf16_f32 v100, v100, v101
  v_cvt_pk_bf16_f32 v101, v102, v103
  v_mfma_f32_16x16x32_bf16 v[152:155], a[172:175], a[156:159], v[152:155]
  ds_read_b128 a[20:23], v254 offset:1024
  ds_read_b128 a[28:31], v254 offset:17408
  s_waitcnt lgkmcnt(14)
  buffer_store_dwordx4 v[64:67], v235, s[24:27], s65 offen sc0 sc1 nt
  ds_write_b64 v227, v[100:101] offset:4096
  v_cvt_pk_bf16_f32 v104, v104, v105
  v_cvt_pk_bf16_f32 v105, v106, v107
  v_mfma_f32_16x16x32_bf16 v[156:159], a[176:179], a[144:147], v[180:183]
  ds_read_b128 a[36:39], v253 offset:1024
  ds_read_b128 a[44:47], v253 offset:17408
  ds_write_b64 v228, v[104:105] offset:4096
  v_cvt_pk_bf16_f32 v108, v108, v109
  v_cvt_pk_bf16_f32 v109, v110, v111
  v_mfma_f32_16x16x32_bf16 v[156:159], a[180:183], a[148:151], v[156:159]
  ds_write_b64 v229, v[108:109] offset:4096
  v_add_u32 v218, s61, v211
  v_add_u32 v219, s61, v214
  v_cvt_pk_bf16_f32 v112, v112, v113
  v_cvt_pk_bf16_f32 v113, v114, v115
  v_mfma_f32_16x16x32_bf16 v[156:159], a[184:187], a[152:155], v[156:159]
  ds_write_b64 v226, v[112:113] offset:4224
  v_add_u32 v230, s61, v212
  v_add_u32 v231, s61, v215
  v_cvt_pk_bf16_f32 v116, v116, v117
  v_cvt_pk_bf16_f32 v117, v118, v119
  v_mfma_f32_16x16x32_bf16 v[156:159], a[188:191], a[156:159], v[156:159]
  s_waitcnt lgkmcnt(15)
  buffer_store_dwordx4 v[68:71], v235, s[24:27], s65 offen offset:1024 sc0 sc1 nt
  ds_write_b64 v227, v[116:117] offset:4224
  v_exp_f32 v144, v144
  v_cvt_pk_bf16_f32 v120, v120, v121
  v_cvt_pk_bf16_f32 v121, v122, v123
  s_waitcnt lgkmcnt(13)
  v_mfma_f32_16x16x32_bf16 a[0:3], a[192:195], a[16:19], a[0:3]
  ds_write_b64 v228, v[120:121] offset:4224
  v_exp_f32 v145, v145
  v_cvt_pk_bf16_f32 v124, v124, v125
  v_cvt_pk_bf16_f32 v125, v126, v127
  v_mfma_f32_16x16x32_bf16 a[4:7], a[196:199], a[16:19], a[4:7]
  s_waitcnt lgkmcnt(10)
  ds_write_b64 v229, v[124:125] offset:4224
  ds_read_b128 v[80:83], v233 offset:4096
  ds_read_b128 v[84:87], v234 offset:5120
  ds_read_b128 v[88:91], v233 offset:6144
  ds_read_b128 v[92:95], v234 offset:7168
  v_exp_f32 v146, v146
  v_cvt_pk_bf16_f32 v144, v144, v145
  v_mfma_f32_16x16x32_bf16 a[0:3], a[200:203], a[24:27], a[0:3]
  v_exp_f32 v147, v147
  v_mfma_f32_16x16x32_bf16 a[4:7], a[204:207], a[24:27], a[4:7]
  buffer_store_dwordx4 v[72:75], v235, s[24:27], s65 offen offset:2048 sc0 sc1 nt
  v_exp_f32 v148, v148
  v_cvt_pk_bf16_f32 v145, v146, v147
  v_mfma_f32_16x16x32_bf16 a[0:3], a[208:211], a[32:35], a[0:3]
  v_exp_f32 v149, v149
TP24:
  s_cbranch_execz L_TRET
  v_mfma_f32_16x16x32_bf16 a[4:7], a[212:215], a[32:35], a[4:7]
  v_exp_f32 v150, v150
  v_cvt_pk_bf16_f32 v146, v148, v149
  v_mfma_f32_16x16x32_bf16 a[0:3], a[216:219], a[40:43], a[0:3]
  v_exp_f32 v151, v151
  v_mfma_f32_16x16x32_bf16 a[4:7], a[220:223], a[40:43], a[4:7]
  buffer_store_dwordx4 v[76:79], v235, s[24:27], s65 offen offset:3072 sc0 sc1 nt
  v_exp_f32 v152, v152
  v_cvt_pk_bf16_f32 v147, v150, v151
  v_mfma_f32_16x16x32_bf16 v[200:203], a[224:227], v[128:131], v[200:203]
  s_waitcnt lgkmcnt(7)
  ds_write_b128 v255, v[144:147]
  v_exp_f32 v153, v153
  v_mfma_f32_16x16x32_bf16 a[8:11], a[192:195], a[20:23], a[8:11]
  v_exp_f32 v154, v154
  v_cvt_pk_bf16_f32 v152, v152, v153
  v_mfma_f32_16x16x32_bf16 a[12:15], a[196:199], a[20:23], a[12:15]
  ds_read_b64_tr_b16 a[192:193], v218 offset:40960
  ds_read_b64_tr_b16 a[194:195], v218 offset:45056
  v_exp_f32 v155, v155
  v_mfma_f32_16x16x32_bf16 a[8:11], a[200:203], a[28:31], a[8:11]
  ds_read_b64_tr_b16 a[196:197], v219 offset:40960
  ds_read_b64_tr_b16 a[198:199], v219 offset:45056
  s_waitcnt lgkmcnt(5)
  buffer_store_dwordx4 v[80:83], v235, s[24:27], s66 offen sc0 sc1 nt
  v_exp_f32 v156, v156
  v_cvt_pk_bf16_f32 v153, v154, v155
  v_mfma_f32_16x16x32_bf16 a[12:15], a[204:207], a[28:31], a[12:15]
  ds_read_b64_tr_b16 a[200:201], v218 offset:57344
  ds_read_b64_tr_b16 a[202:203], v218 offset:61440
  v_exp_f32 v157, v157
  v_mfma_f32_16x16x32_bf16 a[8:11], a[208:211], a[36:39], a[8:11]
  ds_read_b64_tr_b16 a[204:205], v219 offset:57344
  ds_read_b64_tr_b16 a[206:207], v219 offset:61440
  v_exp_f32 v158, v158
  v_mfma_f32_16x16x32_bf16 a[12:15], a[212:215], a[36:39], a[12:15]
  v_exp_f32 v159, v159
  v_mfma_f32_16x16x32_bf16 a[8:11], a[216:219], a[44:47], a[8:11]
  buffer_store_dwordx4 v[84:87], v235, s[24:27], s66 offen offset:1024 sc0 sc1 nt
  v_cvt_pk_bf16_f32 v154, v156, v157
  v_cvt_pk_bf16_f32 v155, v158, v159
  v_mfma_f32_16x16x32_bf16 a[12:15], a[220:223], a[44:47], a[12:15]
  ds_write_b128 v255, v[152:155] offset:1024
  v_mfma_f32_16x16x32_bf16 v[204:207], a[224:227], v[136:139], v[204:207]
  v_mfma_f32_16x16x32_bf16 v[200:203], a[224:227], v[144:147], v[200:203]
  v_mfma_f32_16x16x32_bf16 v[204:207], a[224:227], v[152:155], v[204:207]
  v_add_u32 v254, 65536, v253
  ds_read_b64_tr_b16 a[208:209], v230 offset:8192
  ds_read_b64_tr_b16 a[210:211], v230 offset:12288
  ds_read_b64_tr_b16 a[212:213], v231 offset:8192
  ds_read_b64_tr_b16 a[214:215], v231 offset:12288
  ds_read_b64_tr_b16 a[216:217], v230 offset:24576
  ds_read_b64_tr_b16 a[218:219], v230 offset:28672
  ds_read_b64_tr_b16 a[220:221], v231 offset:24576
  ds_read_b64_tr_b16 a[222:223], v231 offset:28672
  ds_write_b32 v245, v200 offset:4096
  ds_write_b32 v245, v204 offset:4352
  ds_write_b32 v247, v232 offset:5120
  v_accvgpr_read_b32 v0, a0
  v_accvgpr_read_b32 v1, a1
  v_accvgpr_read_b32 v2, a2
  v_accvgpr_read_b32 v3, a3
  v_accvgpr_read_b32 v4, a4
  v_accvgpr_read_b32 v5, a5
  v_accvgpr_read_b32 v6, a6
  v_accvgpr_read_b32 v7, a7
  s_waitcnt lgkmcnt(0)
  s_barrier
  ds_read_b128 a[16:19], v253 offset:32768
  ds_read_b128 a[24:27], v253 offset:49152
  ds_read_b128 a[32:35], v254
  ds_read_b128 a[40:43], v254 offset:16384
  ds_read_b128 v[160:163], v246 offset:4096
  ds_read_b128 v[164:167], v246 offset:4352
  ds_read_b128 a[20:23], v253 offset:33792
  ds_read_b128 a[28:31], v253 offset:50176
  ds_read_b128 a[36:39], v254 offset:1024
  ds_read_b128 a[44:47], v254 offset:17408
  ds_read_b128 v[168:171], v235 offset:5120
  v_accvgpr_read_b32 v8, a8
  v_accvgpr_read_b32 v9, a9
  v_accvgpr_read_b32 v10, a10
  v_accvgpr_read_b32 v11, a11
  v_accvgpr_read_b32 v12, a12
  v_accvgpr_read_b32 v13, a13
  v_accvgpr_read_b32 v14, a14
  v_accvgpr_read_b32 v15, a15
  buffer_store_dwordx4 v[88:91], v235, s[24:27], s66 offen offset:2048 sc0 sc1 nt
  s_waitcnt lgkmcnt(10)
  v_mfma_f32_16x16x32_bf16 v[0:3], a[192:195], a[16:19], v[0:3]
  v_mfma_f32_16x16x32_bf16 v[4:7], a[196:199], a[16:19], v[4:7]
  s_waitcnt lgkmcnt(9)
  buffer_store_dwordx4 v[92:95], v235, s[24:27], s66 offen offset:3072 sc0 sc1 nt
  v_mfma_f32_16x16x32_bf16 v[0:3], a[200:203], a[24:27], v[0:3]
  s_waitcnt lgkmcnt(6)
  v_add_f32 v160, v160, v161
  v_add_f32 v162, v162, v163
  v_mfma_f32_16x16x32_bf16 v[4:7], a[204:207], a[24:27], v[4:7]
  v_add_f32 v160, v160, v162
  v_subrev_u32 v161, s31, v160
  v_mfma_f32_16x16x32_bf16 v[0:3], a[208:211], a[32:35], v[0:3]
  v_rcp_f32 v160, v160
  v_mfma_f32_16x16x32_bf16 v[4:7], a[212:215], a[32:35], v[4:7]
  s_waitcnt lgkmcnt(5)
  v_add_f32 v164, v164, v165
  v_add_f32 v166, v166, v167
  v_mfma_f32_16x16x32_bf16 v[0:3], a[216:219], a[40:43], v[0:3]
  v_add_f32 v164, v164, v166
  v_subrev_u32 v165, s31, v164
  v_mfma_f32_16x16x32_bf16 v[4:7], a[220:223], a[40:43], v[4:7]
  s_waitcnt lgkmcnt(4)
  v_rcp_f32 v164, v164
  v_mfma_f32_16x16x32_bf16 v[8:11], a[192:195], a[20:23], v[8:11]
  v_mfma_f32_16x16x32_bf16 v[12:15], a[196:199], a[20:23], v[12:15]
  s_waitcnt lgkmcnt(0)
  v_mul_f32 v0, v0, v160
  v_mul_f32 v1, v1, v160
  v_mul_f32 v2, v2, v160
  v_mfma_f32_16x16x32_bf16 v[8:11], a[200:203], a[28:31], v[8:11]
  v_mul_f32 v3, v3, v160
  v_mul_f32 v4, v4, v160
  v_mfma_f32_16x16x32_bf16 v[12:15], a[204:207], a[28:31], v[12:15]
  v_mul_f32 v5, v5, v160
  v_mul_f32 v6, v6, v160
  v_mfma_f32_16x16x32_bf16 v[8:11], a[208:211], a[36:39], v[8:11]
  v_mul_f32 v7, v7, v160
  v_cvt_pk_bf16_f32 v0, v0, v1
  v_cvt_pk_bf16_f32 v1, v2, v3
  v_mfma_f32_16x16x32_bf16 v[12:15], a[212:215], a[36:39], v[12:15]
  v_cvt_pk_bf16_f32 v2, v4, v5
  v_cvt_pk_bf16_f32 v3, v6, v7
  v_mfma_f32_16x16x32_bf16 v[8:11], a[216:219], a[44:47], v[8:11]
  s_nop 1
  v_permlane16_swap_b32 v0, v2
  v_mfma_f32_16x16x32_bf16 v[12:15], a[220:223], a[44:47], v[12:15]
  v_permlane16_swap_b32 v1, v3
  buffer_store_dwordx4 v[0:3], v243, s[24:27], s49 offen sc0 sc1 nt
  s_add_u32 s49, s49, 4096
  s_nop 0
  v_pk_mul_f32 v[8:9], v[8:9], v[164:165] op_sel:[0,0] op_sel_hi:[1,0]
  v_pk_mul_f32 v[10:11], v[10:11], v[164:165] op_sel:[0,0] op_sel_hi:[1,0]
  s_nop 1
  v_pk_mul_f32 v[12:13], v[12:13], v[164:165] op_sel:[0,0] op_sel_hi:[1,0]
  v_pk_mul_f32 v[14:15], v[14:15], v[164:165] op_sel:[0,0] op_sel_hi:[1,0]
  v_cvt_pk_bf16_f32 v8, v8, v9
  v_cvt_pk_bf16_f32 v9, v10, v11
  v_cvt_pk_bf16_f32 v10, v12, v13
  v_cvt_pk_bf16_f32 v11, v14, v15
  s_nop 1
  v_permlane16_swap_b32 v8, v10
  v_permlane16_swap_b32 v9, v11
  buffer_store_dwordx4 v[8:11], v243, s[24:27], s49 offen sc0 sc1 nt
  v_cmp_le_u32 s[62:63], s32, v161
  s_nop 1
  v_cndmask_b32 v168, v168, v236, s[62:63]
  v_cmp_le_u32 s[62:63], s32, v165
  s_nop 1
  v_cndmask_b32 v168, v168, v236, s[62:63]
  v_or3_b32 v168, v168, v169, v170
  v_or_b32 v168, v168, v171
TP25:
  s_cbranch_execz L_TRET
  v_cmp_ne_u32 vcc, 0, v168
  s_cmp_eq_u32 s38, 0
  s_nop 2
  s_cselect_b64 s[62:63], vcc, 0
  s_cmp_lg_u64 s[62:63], 0
  s_cbranch_scc1 L_FB
L_FIN:
L_end:
  s_endpgm
L_FB:
  s_mov_b32 s38, 1
  s_mov_b32 s42, 0
  v_mov_b32 v226, 0xff800000
  v_mov_b32 v227, 0xff800000
  v_mov_b32 v228, 0xff800000
  v_mov_b32 v229, 0xff800000
  v_mov_b32 v230, 0xff800000
  v_mov_b32 v231, 0xff800000
  s_waitcnt vmcnt(0) lgkmcnt(0)
L_FB_LOAD:
  s_barrier
  s_mov_b32 m0, s29
  s_lshl_b32 s39, s42, 13
  buffer_load_dwordx4 v220, s[16:19], s39 offen nt lds
  buffer_load_dwordx4 v221, s[16:19], s39 offen offset:1024 nt lds
  s_waitcnt vmcnt(0)
  s_barrier
  ds_read_b128 a[160:163], v208
  ds_read_b128 a[164:167], v208 offset:256
  ds_read_b128 a[168:171], v208 offset:512
  ds_read_b128 a[172:175], v208 offset:768
  ds_read_b128 a[176:179], v208 offset:4096
  ds_read_b128 a[180:183], v208 offset:4352
  ds_read_b128 a[184:187], v208 offset:4608
  ds_read_b128 a[188:191], v208 offset:4864
  s_waitcnt lgkmcnt(0)
  v_mfma_f32_16x16x32_bf16 v[128:131], a[160:163], a[64:67], 0
  v_mfma_f32_16x16x32_bf16 v[128:131], a[164:167], a[68:71], v[128:131]
  v_mfma_f32_16x16x32_bf16 v[128:131], a[168:171], a[72:75], v[128:131]
  v_mfma_f32_16x16x32_bf16 v[128:131], a[172:175], a[76:79], v[128:131]
  v_mfma_f32_16x16x32_bf16 v[132:135], a[176:179], a[64:67], 0
  v_mfma_f32_16x16x32_bf16 v[132:135], a[180:183], a[68:71], v[132:135]
  v_mfma_f32_16x16x32_bf16 v[132:135], a[184:187], a[72:75], v[132:135]
  v_mfma_f32_16x16x32_bf16 v[132:135], a[188:191], a[76:79], v[132:135]
  v_mfma_f32_16x16x32_bf16 v[136:139], a[160:163], a[80:83], 0
  v_mfma_f32_16x16x32_bf16 v[136:139], a[164:167], a[84:87], v[136:139]
  v_mfma_f32_16x16x32_bf16 v[136:139], a[168:171], a[88:91], v[136:139]
  v_mfma_f32_16x16x32_bf16 v[136:139], a[172:175], a[92:95], v[136:139]
  v_mfma_f32_16x16x32_bf16 v[140:143], a[176:179], a[80:83], 0
  v_mfma_f32_16x16x32_bf16 v[140:143], a[180:183], a[84:87], v[140:143]
  v_mfma_f32_16x16x32_bf16 v[140:143], a[184:187], a[88:91], v[140:143]
  v_mfma_f32_16x16x32_bf16 v[140:143], a[188:191], a[92:95], v[140:143]
  s_nop 7
  s_nop 7
  v_max3_f32 v226, v226, v128, v129
  v_max3_f32 v227, v227, v136, v137
  v_max3_f32 v226, v226, v130, v131
  v_max3_f32 v227, v227, v138, v139
  v_max3_f32 v226, v226, v132, v133
  v_max3_f32 v227, v227, v140, v141
  v_max3_f32 v226, v226, v134, v135
  v_max3_f32 v227, v227, v142, v143
  s_nop 1
  v_mfma_f32_16x16x32_bf16 v[128:131], a[160:163], a[96:99], 0
  v_mfma_f32_16x16x32_bf16 v[128:131], a[164:167], a[100:103], v[128:131]
  v_mfma_f32_16x16x32_bf16 v[128:131], a[168:171], a[104:107], v[128:131]
  v_mfma_f32_16x16x32_bf16 v[128:131], a[172:175], a[108:111], v[128:131]
  v_mfma_f32_16x16x32_bf16 v[132:135], a[176:179], a[96:99], 0
  v_mfma_f32_16x16x32_bf16 v[132:135], a[180:183], a[100:103], v[132:135]
  v_mfma_f32_16x16x32_bf16 v[132:135], a[184:187], a[104:107], v[132:135]
  v_mfma_f32_16x16x32_bf16 v[132:135], a[188:191], a[108:111], v[132:135]
  v_mfma_f32_16x16x32_bf16 v[136:139], a[160:163], a[112:115], 0
  v_mfma_f32_16x16x32_bf16 v[136:139], a[164:167], a[116:119], v[136:139]
  v_mfma_f32_16x16x32_bf16 v[136:139], a[168:171], a[120:123], v[136:139]
  v_mfma_f32_16x16x32_bf16 v[136:139], a[172:175], a[124:127], v[136:139]
  v_mfma_f32_16x16x32_bf16 v[140:143], a[176:179], a[112:115], 0
  v_mfma_f32_16x16x32_bf16 v[140:143], a[180:183], a[116:119], v[140:143]
  v_mfma_f32_16x16x32_bf16 v[140:143], a[184:187], a[120:123], v[140:143]
  v_mfma_f32_16x16x32_bf16 v[140:143], a[188:191], a[124:127], v[140:143]
  s_nop 7
  s_nop 7
  v_max3_f32 v228, v228, v128, v129
  v_max3_f32 v229, v229, v136, v137
  v_max3_f32 v228, v228, v130, v131
  v_max3_f32 v229, v229, v138, v139
  v_max3_f32 v228, v228, v132, v133
  v_max3_f32 v229, v229, v140, v141
  v_max3_f32 v228, v228, v134, v135
  v_max3_f32 v229, v229, v142, v143
  s_nop 1
  v_mfma_f32_16x16x32_bf16 v[128:131], a[160:163], a[128:131], 0
  v_mfma_f32_16x16x32_bf16 v[128:131], a[164:167], a[132:135], v[128:131]
  v_mfma_f32_16x16x32_bf16 v[128:131], a[168:171], a[136:139], v[128:131]
  v_mfma_f32_16x16x32_bf16 v[128:131], a[172:175], a[140:143], v[128:131]
  v_mfma_f32_16x16x32_bf16 v[132:135], a[176:179], a[128:131], 0
  v_mfma_f32_16x16x32_bf16 v[132:135], a[180:183], a[132:135], v[132:135]
  v_mfma_f32_16x16x32_bf16 v[132:135], a[184:187], a[136:139], v[132:135]
  v_mfma_f32_16x16x32_bf16 v[132:135], a[188:191], a[140:143], v[132:135]
  v_mfma_f32_16x16x32_bf16 v[136:139], a[160:163], a[144:147], 0
  v_mfma_f32_16x16x32_bf16 v[136:139], a[164:167], a[148:151], v[136:139]
  v_mfma_f32_16x16x32_bf16 v[136:139], a[168:171], a[152:155], v[136:139]
  v_mfma_f32_16x16x32_bf16 v[136:139], a[172:175], a[156:159], v[136:139]
  v_mfma_f32_16x16x32_bf16 v[140:143], a[176:179], a[144:147], 0
  v_mfma_f32_16x16x32_bf16 v[140:143], a[180:183], a[148:151], v[140:143]
  v_mfma_f32_16x16x32_bf16 v[140:143], a[184:187], a[152:155], v[140:143]
  v_mfma_f32_16x16x32_bf16 v[140:143], a[188:191], a[156:159], v[140:143]
  s_nop 7
  s_nop 7
  v_max3_f32 v230, v230, v128, v129
  v_max3_f32 v231, v231, v136, v137
  v_max3_f32 v230, v230, v130, v131
  v_max3_f32 v231, v231, v138, v139
  v_max3_f32 v230, v230, v132, v133
  v_max3_f32 v231, v231, v140, v141
  v_max3_f32 v230, v230, v134, v135
  v_max3_f32 v231, v231, v142, v143
  s_nop 1
  s_add_u32 s42, s42, 1
  s_cmp_lt_u32 s42, 16
  s_cbranch_scc1 L_FB_LOAD
  s_barrier
  s_branch L_RESTART
.section .rodata,"a"
.p2align 6
.amdhsa_kernel standalone__gqa_softmax__near_ridge_kernel
  .amdhsa_next_free_vgpr 512
  .amdhsa_next_free_sgpr 80
  .amdhsa_accum_offset 256
  .amdhsa_group_segment_fixed_size 0
  .amdhsa_kernarg_size 48
  .amdhsa_user_sgpr_count 2
  .amdhsa_user_sgpr_kernarg_segment_ptr 1
  .amdhsa_system_sgpr_workgroup_id_x 1
.end_amdhsa_kernel
```
